```python
import torch

def _softmax(x, axis=-1):
    return torch.softmax(x, dim=axis)
def _gelu(x):
    return torch.nn.functional.gelu(x, approximate="tanh")
def _silu(x):
    return torch.nn.functional.silu(x)
def _sigmoid(x):
    return torch.sigmoid(x)
def _layernorm(x, axis=-1, eps=1e-5):
    m = x.mean(dim=axis, keepdim=True)
    v = x.var(dim=axis, keepdim=True, unbiased=False)
    return (x - m) / torch.sqrt(v + eps)
def _scatter_add(tgt, idx, src, axis=0):
    return tgt.clone().index_add_(axis, idx, src)
def _segment_sum(src, seg, n):
    out = torch.zeros((n,) + src.shape[1:], dtype=src.dtype)
    return out.index_add_(0, seg, src)
def _pad(x, pw):
    flat = tuple(v for pair in reversed(pw) for v in pair)
    return torch.nn.functional.pad(x, flat)

kernel_name = 'gated_mix__linear_attn_block__geglu_ffn__prompt'

def setup_inputs():

    _w = (lambda a: (lambda t: t.to(torch.bfloat16) if t.is_floating_point() else t)(torch.as_tensor(a)))
    def _A_setup():
        B, S, D = 1, 2048, 576
        return {
            "x": _w((lambda *s: torch.randn(*s, dtype=torch.bfloat16) * 0.05)(B, S, D)),
            "wqkv": _w((lambda *s: torch.randn(*s, dtype=torch.bfloat16) * 0.8)(D, 3 * D)),
            "wo": _w((lambda *s: torch.randn(*s, dtype=torch.bfloat16) * 0.05)(D, D)),
        }
    _A_in = _A_setup()

    def _B_setup():
        B, S, D, F = 1, 2048, 576, 4608
        return {
            "x": _w((lambda *s: torch.randn(*s, dtype=torch.bfloat16) * 0.05)(B, S, D)),
            "w_gate": _w((lambda *s: torch.randn(*s, dtype=torch.bfloat16) * 0.05)(D, F)),
            "w_up": _w((lambda *s: torch.randn(*s, dtype=torch.bfloat16) * 0.05)(D, F)),
            "w_down": _w((lambda *s: torch.randn(*s, dtype=torch.bfloat16) * 0.05)(F, D)),
        }
    _B_in = _B_setup()

    return {
        "A_x": _A_in["x"],
        "A_wqkv": _A_in["wqkv"],
        "A_wo": _A_in["wo"],
        "B_x": _B_in["x"],
        "B_w_gate": _B_in["w_gate"],
        "B_w_up": _B_in["w_up"],
        "B_w_down": _B_in["w_down"],
        "gate_w": _w((lambda *s: torch.randn(*s, dtype=torch.bfloat16) * 0.05)(576) * 16.0),
    }

def reference(A_x, A_wqkv, A_wo, B_x, B_w_gate, B_w_up, B_w_down, gate_w):
    def _A_ref(x, wqkv, wo):
        B, S, D = x.shape
        H = 32; Dh = D // H
        qkv = (lambda x, *d: x.permute(*d))((x @ wqkv).reshape(B, S, 3, H, Dh), 2, 0, 3, 1, 4)
        q, k, v = qkv[0], qkv[1], qkv[2]
        phi = lambda t: torch.where(t > 0, t + 1, torch.exp(t)) + 1e-6
        pq, pk = phi(q), phi(k)
        kv = torch.einsum("bhsd,bhse->bhde", pk, v)
        z = torch.einsum("bhsd->bhd", pk)
        num = torch.einsum("bhqd,bhde->bhqe", pq, kv)
        den = torch.einsum("bhqd,bhd->bhq", pq, z)[..., None] + 1e-6
        o = num / den
        return (lambda x, *d: x.permute(*d))(o, 0, 2, 1, 3).reshape(B, S, D) @ wo

    def _B_ref(x, w_gate, w_up, w_down):
        return (_gelu(x @ w_gate) * (x @ w_up)) @ w_down

    x = A_x
    g = _sigmoid((x * gate_w).sum(-1, keepdims=True))
    a = _A_ref(x, A_wqkv, A_wo)
    b = _B_ref(x, B_w_gate, B_w_up, B_w_down)
    return g * a + (1 - g) * b
```

```asm
; @launch kernel=k1_kernel grid=(256,1,1) block=(512,1,1) lds=163840
.amdgcn_target "amdgcn-amd-amdhsa--gfx950"
.text
.globl k1_kernel
.p2align 8
.type k1_kernel,@function
k1_kernel:
    s_cmp_ge_u32 s2, 256
    s_cbranch_scc1 k1_exit
    s_load_dwordx16 s[48:63], s[0:1], 0
    s_load_dwordx4 s[64:67], s[0:1], 64
    s_load_dwordx2 s[68:69], s[0:1], 80
    v_and_b32 v14, 63, v0
    v_lshrrev_b32 v15, 6, v0
    s_nop 0
    v_readfirstlane_b32 s24, v15
    v_lshrrev_b32 v15, 3, v14
    v_mul_u32_u24 v8, 1152, v15
    v_lshrrev_b32 v15, 4, v14
    v_and_b32 v13, 7, v14
    v_xor_b32 v13, v13, v15
    v_lshl_add_u32 v9, v13, 4, v8
    v_xor_b32 v13, 4, v13
    v_lshl_add_u32 v13, v13, 4, v8
    v_mov_b32 v8, v9
    v_add_u32 v9, 9216, v13
    s_cmp_lg_u32 s24, 0
    s_cbranch_scc1 npfc_1
    s_getpc_b64 s[16:17]
pc_2:
    s_add_u32 s16, s16, k1_kernel-pc_2
    s_addc_u32 s17, s17, (k1_kernel-pc_2)>>32
    s_and_b32 s17, s17, 0xffff
    s_mov_b32 s18, code_end-k1_kernel
    s_mov_b32 s19, 0x00020000
    s_lshr_b32 s20, s2, 3
    s_lshl_b32 s20, s20, 11
    v_lshlrev_b32 v40, 4, v14
    buffer_load_dwordx4 v[44:47], v40, s[16:19], s20 offen offset:1024
    buffer_load_dwordx4 v[40:43], v40, s[16:19], s20 offen
npfc_1:
    s_waitcnt lgkmcnt(0)
    s_mov_b32 s4, s48
    s_and_b32 s5, s49, 0xffff
    s_mov_b32 s6, 2359296
    s_mov_b32 s7, 0x00020000
    s_mov_b32 s12, s68
    s_and_b32 s13, s69, 0xffff
    s_mov_b32 s14, 67108864
    s_mov_b32 s15, 0x00020000
    s_cmp_lg_u32 s2, 0
    s_cbranch_scc1 nzero_3
    s_cmp_lg_u32 s24, 7
    s_cbranch_scc1 nzero_3
    s_mov_b32 s20, s66
    s_and_b32 s21, s67, 0xffff
    s_mov_b32 s22, 256
    s_mov_b32 s23, 0x00020000
    v_mov_b32 v20, 0
    v_mov_b32 v21, 0
    v_mov_b32 v22, 0
    v_mov_b32 v23, 0
    v_lshlrev_b32 v24, 4, v14
    s_mov_b32 s36, 45154304
    buffer_store_dwordx4 v[20:23], v24, s[12:15], s36 offen sc1
    buffer_store_dwordx4 v[20:23], v24, s[12:15], s36 offen offset:1024 sc1
    buffer_store_dwordx4 v[20:23], v24, s[12:15], s36 offen offset:2048 sc1
    v_mov_b32 v25, 1
    s_waitcnt vmcnt(0)
    s_mov_b64 exec, 1
    buffer_store_dword v25, v20, s[20:23], 0 offen sc1
    s_mov_b64 exec, -1
nzero_3:
    s_and_b32 s36, s2, 7
    s_lshr_b32 s37, s2, 3
    s_cmp_lt_u32 s37, 8
    s_cbranch_scc1 k1_qkv
    s_sub_u32 s37, s37, 8
    s_and_b32 s25, s37, 7
    s_lshr_b32 s37, s37, 3
    s_mul_i32 s26, s36, 3
    s_add_u32 s26, s26, s37
    s_cmp_lt_u32 s24, 4
    s_cselect_b32 s36, s56, s58
    s_cselect_b32 s37, s57, s59
    s_mov_b32 s8, s36
    s_and_b32 s9, s37, 0xffff
    s_mov_b32 s10, 5308416
    s_mov_b32 s11, 0x00020000
    s_lshl_b32 s36, s25, 8
    s_lshl_b32 s37, s24, 5
    s_add_u32 s36, s36, s37
    s_mul_i32 s27, s36, 1152
    s_add_u32 s28, s27, 18432
    s_lshl_b32 s30, s24, 12
    s_and_b32 s36, s24, 3
    s_mul_i32 s29, s36, 73728
    s_mul_i32 s37, s26, 384
    s_add_u32 s29, s29, s37
    s_mov_b32 s85, 294912
    s_and_b32 s36, s24, 3
    s_mul_i32 s35, s36, 3072
    s_cmp_lt_u32 s24, 4
    s_cselect_b32 s37, 0, 49152
    s_add_u32 s35, s35, s37
    s_add_u32 s35, s35, 65536
    s_mov_b32 s31, s35
    s_mov_b32 s34, 0
    s_mov_b32 s33, 12288
    v_add_u32 v15, 0, v14
    v_mul_u32_u24 v16, 2731, v15
    v_lshrrev_b32 v16, 16, v16
    v_mul_u32_u24 v17, 24, v16
    v_sub_u32 v15, v15, v17
    v_and_b32 v18, 3, v15
    v_lshlrev_b32 v18, 4, v18
    v_lshrrev_b32 v17, 2, v15
    v_bfe_u32 v15, v16, 1, 1
    v_xor_b32 v17, v17, v15
    v_mul_u32_u24 v10, 9216, v16
    v_lshl_add_u32 v10, v17, 6, v10
    v_add_u32 v10, v10, v18
    v_add_u32 v15, 64, v14
    v_mul_u32_u24 v16, 2731, v15
    v_lshrrev_b32 v16, 16, v16
    v_mul_u32_u24 v17, 24, v16
    v_sub_u32 v15, v15, v17
    v_and_b32 v18, 3, v15
    v_lshlrev_b32 v18, 4, v18
    v_lshrrev_b32 v17, 2, v15
    v_bfe_u32 v15, v16, 1, 1
    v_xor_b32 v17, v17, v15
    v_mul_u32_u24 v11, 9216, v16
    v_lshl_add_u32 v11, v17, 6, v11
    v_add_u32 v11, v11, v18
    v_add_u32 v15, 128, v14
    v_mul_u32_u24 v16, 2731, v15
    v_lshrrev_b32 v16, 16, v16
    v_mul_u32_u24 v17, 24, v16
    v_sub_u32 v15, v15, v17
    v_and_b32 v18, 3, v15
    v_lshlrev_b32 v18, 4, v18
    v_lshrrev_b32 v17, 2, v15
    v_bfe_u32 v15, v16, 1, 1
    v_xor_b32 v17, v17, v15
    v_mul_u32_u24 v12, 9216, v16
    v_lshl_add_u32 v12, v17, 6, v12
    v_add_u32 v12, v12, v18
    s_lshl_b32 s36, s26, 3
    s_add_u32 s36, s36, s25
    s_lshl_b32 s36, s36, 3
    s_add_u32 s36, s36, s24
    s_mul_i32 s87, s36, 9216
    s_add_u32 s87, s87, 21602304
    s_mov_b32 s83, s27
    s_mov_b32 s84, s28
    s_add_u32 s27, s27, 128
    s_add_u32 s28, s28, 128
    s_add_u32 m0, s30, 0
    s_nop 0
    buffer_load_dwordx4 v8, s[4:7], s83 offen lds
    s_add_u32 m0, s30, 1024
    s_nop 0
    buffer_load_dwordx4 v9, s[4:7], s83 offen lds
    s_add_u32 m0, s30, 2048
    s_nop 0
    buffer_load_dwordx4 v8, s[4:7], s84 offen lds
    s_add_u32 m0, s30, 3072
    s_nop 0
    buffer_load_dwordx4 v9, s[4:7], s84 offen lds
    s_xor_b32 s30, s30, 32768
    s_mov_b32 s82, s29
    s_add_u32 s29, s29, s85
    s_add_u32 m0, s31, 0
    s_nop 0
    buffer_load_dwordx4 v10, s[8:11], s82 offen lds
    s_add_u32 m0, s31, 1024
    s_nop 0
    buffer_load_dwordx4 v11, s[8:11], s82 offen lds
    s_add_u32 m0, s31, 2048
    s_nop 0
    buffer_load_dwordx4 v12, s[8:11], s82 offen lds
    s_add_u32 s34, s34, 1
    s_and_b32 s34, s34, 3
    s_mul_i32 s31, s34, 12288
    s_add_u32 s31, s31, s35
    s_lshl_b32 s36, s26, 3
    s_add_u32 s36, s36, s25
    s_cmp_lt_u32 s36, 162
    s_cselect_b32 s78, s60, s52
    s_cselect_b32 s79, s61, s53
    s_mov_b32 s80, 663552
    s_cselect_b32 s80, 5308416, s80
    s_cselect_b32 s37, 0, 162
    s_sub_u32 s36, s36, s37
    s_and_b32 s79, s79, 0xffff
    s_mul_i32 s37, s36, 7282
    s_lshr_b32 s37, s37, 16
    s_mul_i32 s38, s37, 9
    s_sub_u32 s38, s36, s38
    s_lshl_b32 s37, s37, 8
    s_lshl_b32 s39, s24, 5
    s_add_u32 s37, s37, s39
    s_mul_i32 s81, s37, 1152
    s_lshl_b32 s38, s38, 7
    s_add_u32 s81, s81, s38
    s_and_b32 s36, s24, 3
    s_lshl_b32 s36, s36, 6
    v_and_b32 v15, 31, v14
    v_add_u32 v15, s36, v15
    v_lshlrev_b32 v4, 7, v15
    v_bfe_u32 v15, v14, 1, 3
    v_lshrrev_b32 v13, 5, v14
    v_xor_b32 v15, v15, v13
    v_lshl_add_u32 v4, v15, 4, v4
    v_xor_b32 v5, 32, v4
    v_xor_b32 v6, 64, v4
    v_xor_b32 v7, 96, v4
    v_lshrrev_b32 v15, 5, v14
    v_lshlrev_b32 v16, 3, v15
    v_bfe_u32 v15, v14, 2, 2
    v_add_u32 v16, v16, v15
    v_mul_u32_u24 v16, 384, v16
    v_lshrrev_b32 v17, 1, v15
    v_bfe_u32 v15, v14, 4, 1
    v_lshl_add_u32 v16, v15, 5, v16
    v_and_b32 v15, 3, v14
    v_lshl_add_u32 v16, v15, 3, v16
    v_add_u32 v16, 65536, v16
    s_lshr_b32 s36, s24, 2
    s_mul_i32 s36, s36, 3
    s_add_u32 s37, s36, 0
    v_xor_b32 v18, s37, v17
    v_lshl_add_u32 v13, v18, 6, v16
    s_add_u32 s37, s36, 1
    v_xor_b32 v18, s37, v17
    v_lshl_add_u32 v14, v18, 6, v16
    s_add_u32 s37, s36, 2
    v_xor_b32 v18, s37, v17
    v_lshl_add_u32 v15, v18, 6, v16
    v_mov_b32 v64, 0
    v_mov_b32 v65, 0
    v_mov_b32 v66, 0
    v_mov_b32 v67, 0
    v_mov_b32 v68, 0
    v_mov_b32 v69, 0
    v_mov_b32 v70, 0
    v_mov_b32 v71, 0
    v_mov_b32 v72, 0
    v_mov_b32 v73, 0
    v_mov_b32 v74, 0
    v_mov_b32 v75, 0
    v_mov_b32 v76, 0
    v_mov_b32 v77, 0
    v_mov_b32 v78, 0
    v_mov_b32 v79, 0
    v_mov_b32 v80, 0
    v_mov_b32 v81, 0
    v_mov_b32 v82, 0
    v_mov_b32 v83, 0
    v_mov_b32 v84, 0
    v_mov_b32 v85, 0
    v_mov_b32 v86, 0
    v_mov_b32 v87, 0
    v_mov_b32 v88, 0
    v_mov_b32 v89, 0
    v_mov_b32 v90, 0
    v_mov_b32 v91, 0
    v_mov_b32 v92, 0
    v_mov_b32 v93, 0
    v_mov_b32 v94, 0
    v_mov_b32 v95, 0
    v_mov_b32 v96, 0
    v_mov_b32 v97, 0
    v_mov_b32 v98, 0
    v_mov_b32 v99, 0
    v_mov_b32 v100, 0
    v_mov_b32 v101, 0
    v_mov_b32 v102, 0
    v_mov_b32 v103, 0
    v_mov_b32 v104, 0
    v_mov_b32 v105, 0
    v_mov_b32 v106, 0
    v_mov_b32 v107, 0
    v_mov_b32 v108, 0
    v_mov_b32 v109, 0
    v_mov_b32 v110, 0
    v_mov_b32 v111, 0
    v_mov_b32 v112, 0
    v_mov_b32 v113, 0
    v_mov_b32 v114, 0
    v_mov_b32 v115, 0
    v_mov_b32 v116, 0
    v_mov_b32 v117, 0
    v_mov_b32 v118, 0
    v_mov_b32 v119, 0
    v_mov_b32 v120, 0
    v_mov_b32 v121, 0
    v_mov_b32 v122, 0
    v_mov_b32 v123, 0
    v_mov_b32 v124, 0
    v_mov_b32 v125, 0
    v_mov_b32 v126, 0
    v_mov_b32 v127, 0
    v_mov_b32 v128, 0
    v_mov_b32 v129, 0
    v_mov_b32 v130, 0
    v_mov_b32 v131, 0
    v_mov_b32 v132, 0
    v_mov_b32 v133, 0
    v_mov_b32 v134, 0
    v_mov_b32 v135, 0
    v_mov_b32 v136, 0
    v_mov_b32 v137, 0
    v_mov_b32 v138, 0
    v_mov_b32 v139, 0
    v_mov_b32 v140, 0
    v_mov_b32 v141, 0
    v_mov_b32 v142, 0
    v_mov_b32 v143, 0
    v_mov_b32 v144, 0
    v_mov_b32 v145, 0
    v_mov_b32 v146, 0
    v_mov_b32 v147, 0
    v_mov_b32 v148, 0
    v_mov_b32 v149, 0
    v_mov_b32 v150, 0
    v_mov_b32 v151, 0
    v_mov_b32 v152, 0
    v_mov_b32 v153, 0
    v_mov_b32 v154, 0
    v_mov_b32 v155, 0
    v_mov_b32 v156, 0
    v_mov_b32 v157, 0
    v_mov_b32 v158, 0
    v_mov_b32 v159, 0
    v_mov_b32 v160, 0
    v_mov_b32 v161, 0
    v_mov_b32 v162, 0
    v_mov_b32 v163, 0
    v_mov_b32 v164, 0
    v_mov_b32 v165, 0
    v_mov_b32 v166, 0
    v_mov_b32 v167, 0
    v_mov_b32 v168, 0
    v_mov_b32 v169, 0
    v_mov_b32 v170, 0
    v_mov_b32 v171, 0
    v_mov_b32 v172, 0
    v_mov_b32 v173, 0
    v_mov_b32 v174, 0
    v_mov_b32 v175, 0
    v_mov_b32 v176, 0
    v_mov_b32 v177, 0
    v_mov_b32 v178, 0
    v_mov_b32 v179, 0
    v_mov_b32 v180, 0
    v_mov_b32 v181, 0
    v_mov_b32 v182, 0
    v_mov_b32 v183, 0
    v_mov_b32 v184, 0
    v_mov_b32 v185, 0
    v_mov_b32 v186, 0
    v_mov_b32 v187, 0
    v_mov_b32 v188, 0
    v_mov_b32 v189, 0
    v_mov_b32 v190, 0
    v_mov_b32 v191, 0
    v_mov_b32 v192, 0
    v_mov_b32 v193, 0
    v_mov_b32 v194, 0
    v_mov_b32 v195, 0
    v_mov_b32 v196, 0
    v_mov_b32 v197, 0
    v_mov_b32 v198, 0
    v_mov_b32 v199, 0
    v_mov_b32 v200, 0
    v_mov_b32 v201, 0
    v_mov_b32 v202, 0
    v_mov_b32 v203, 0
    v_mov_b32 v204, 0
    v_mov_b32 v205, 0
    v_mov_b32 v206, 0
    v_mov_b32 v207, 0
    v_mov_b32 v208, 0
    v_mov_b32 v209, 0
    v_mov_b32 v210, 0
    v_mov_b32 v211, 0
    v_mov_b32 v212, 0
    v_mov_b32 v213, 0
    v_mov_b32 v214, 0
    v_mov_b32 v215, 0
    v_mov_b32 v216, 0
    v_mov_b32 v217, 0
    v_mov_b32 v218, 0
    v_mov_b32 v219, 0
    v_mov_b32 v220, 0
    v_mov_b32 v221, 0
    v_mov_b32 v222, 0
    v_mov_b32 v223, 0
    v_mov_b32 v224, 0
    v_mov_b32 v225, 0
    v_mov_b32 v226, 0
    v_mov_b32 v227, 0
    v_mov_b32 v228, 0
    v_mov_b32 v229, 0
    v_mov_b32 v230, 0
    v_mov_b32 v231, 0
    v_mov_b32 v232, 0
    v_mov_b32 v233, 0
    v_mov_b32 v234, 0
    v_mov_b32 v235, 0
    v_mov_b32 v236, 0
    v_mov_b32 v237, 0
    v_mov_b32 v238, 0
    v_mov_b32 v239, 0
    v_mov_b32 v240, 0
    v_mov_b32 v241, 0
    v_mov_b32 v242, 0
    v_mov_b32 v243, 0
    v_mov_b32 v244, 0
    v_mov_b32 v245, 0
    v_mov_b32 v246, 0
    v_mov_b32 v247, 0
    v_mov_b32 v248, 0
    v_mov_b32 v249, 0
    v_mov_b32 v250, 0
    v_mov_b32 v251, 0
    v_mov_b32 v252, 0
    v_mov_b32 v253, 0
    v_mov_b32 v254, 0
    v_mov_b32 v255, 0
    s_mov_b32 s82, s29
    s_add_u32 s29, s29, s85
    s_add_u32 m0, s31, 0
    s_nop 0
    buffer_load_dwordx4 v10, s[8:11], s82 offen lds
    s_add_u32 m0, s31, 1024
    s_nop 0
    buffer_load_dwordx4 v11, s[8:11], s82 offen lds
    s_add_u32 m0, s31, 2048
    s_nop 0
    buffer_load_dwordx4 v12, s[8:11], s82 offen lds
    s_add_u32 s34, s34, 1
    s_and_b32 s34, s34, 3
    s_mul_i32 s31, s34, 12288
    s_add_u32 s31, s31, s35
    s_waitcnt vmcnt(3)
    s_barrier
    ds_read_b128 v[16:19], v4 offset:0
    ds_read_b128 v[20:23], v4 offset:4096
    ds_read_b128 v[24:27], v5 offset:0
    ds_read_b128 v[28:31], v5 offset:4096
    ds_read_b128 v[32:35], v6 offset:0
    ds_read_b128 v[36:39], v6 offset:4096
    s_waitcnt lgkmcnt(0)
    ds_read_b64_tr_b16 v[48:49], v13 offset:0
    ds_read_b64_tr_b16 v[50:51], v13 offset:1536
    ds_read_b64_tr_b16 v[52:53], v14 offset:0
    ds_read_b64_tr_b16 v[54:55], v14 offset:1536
    ds_read_b64_tr_b16 v[56:57], v15 offset:0
    ds_read_b64_tr_b16 v[58:59], v15 offset:1536
    s_mov_b32 s32, 0
loop_4:
    ds_read_b128 v[40:43], v7 offset:0
    ds_read_b128 v[44:47], v7 offset:4096
    v_xor_b32 v4, 32768, v4
    v_xor_b32 v5, 32768, v5
    v_xor_b32 v6, 32768, v6
    v_xor_b32 v7, 32768, v7
    s_waitcnt lgkmcnt(6)
    v_mfma_f32_32x32x16_bf16 v[64:79], v[48:51], v[16:19], v[64:79]
    ds_read_b64_tr_b16 v[60:61], v13 offset:49152
    v_mfma_f32_32x32x16_bf16 v[80:95], v[48:51], v[20:23], v[80:95]
    ds_read_b64_tr_b16 v[62:63], v13 offset:50688
    s_cmp_lg_u32 s32, 0
    s_cbranch_scc1 nrmp_5
    s_mov_b32 s83, s27
    s_mov_b32 s84, s28
    s_add_u32 s27, s27, 128
    s_add_u32 s28, s28, 128
    s_add_u32 m0, s30, 0
    s_nop 0
    buffer_load_dwordx4 v8, s[4:7], s83 offen lds
    s_add_u32 m0, s30, 1024
    s_nop 0
    buffer_load_dwordx4 v9, s[4:7], s83 offen lds
nrmp_5:
    s_waitcnt lgkmcnt(6)
    v_mfma_f32_32x32x16_bf16 v[96:111], v[52:55], v[16:19], v[96:111]
    ds_read_b64_tr_b16 v[48:49], v14 offset:49152
    v_mfma_f32_32x32x16_bf16 v[112:127], v[52:55], v[20:23], v[112:127]
    ds_read_b64_tr_b16 v[50:51], v14 offset:50688
    s_cmp_lg_u32 s32, 0
    s_cbranch_scc1 nrmp_6
    s_add_u32 m0, s30, 2048
    s_nop 0
    buffer_load_dwordx4 v8, s[4:7], s84 offen lds
    s_add_u32 m0, s30, 3072
    s_nop 0
    buffer_load_dwordx4 v9, s[4:7], s84 offen lds
    s_xor_b32 s30, s30, 32768
nrmp_6:
    s_waitcnt lgkmcnt(6)
    v_mfma_f32_32x32x16_bf16 v[128:143], v[56:59], v[16:19], v[128:143]
    ds_read_b64_tr_b16 v[52:53], v15 offset:49152
    v_mfma_f32_32x32x16_bf16 v[144:159], v[56:59], v[20:23], v[144:159]
    ds_read_b64_tr_b16 v[54:55], v15 offset:50688
    s_cmp_lg_u32 s32, 0
    s_cbranch_scc1 nrmp_7
    s_mov_b32 s82, s29
    s_add_u32 s29, s29, s85
    s_add_u32 m0, s31, 0
    s_nop 0
    buffer_load_dwordx4 v10, s[8:11], s82 offen lds
nrmp_7:
    s_waitcnt lgkmcnt(4)
    v_mfma_f32_32x32x16_bf16 v[160:175], v[60:63], v[16:19], v[160:175]
    ds_read_b64_tr_b16 v[56:57], v13 offset:6144
    v_mfma_f32_32x32x16_bf16 v[176:191], v[60:63], v[20:23], v[176:191]
    ds_read_b64_tr_b16 v[58:59], v13 offset:7680
    s_cmp_lg_u32 s32, 0
    s_cbranch_scc1 nrmp_8
    s_add_u32 m0, s31, 1024
    s_nop 0
    buffer_load_dwordx4 v11, s[8:11], s82 offen lds
nrmp_8:
    s_waitcnt lgkmcnt(4)
    v_mfma_f32_32x32x16_bf16 v[192:207], v[48:51], v[16:19], v[192:207]
    ds_read_b64_tr_b16 v[60:61], v14 offset:6144
    v_mfma_f32_32x32x16_bf16 v[208:223], v[48:51], v[20:23], v[208:223]
    ds_read_b64_tr_b16 v[62:63], v14 offset:7680
    s_cmp_lg_u32 s32, 0
    s_cbranch_scc1 nrmp_9
    s_add_u32 m0, s31, 2048
    s_nop 0
    buffer_load_dwordx4 v12, s[8:11], s82 offen lds
    s_add_u32 s34, s34, 1
    s_and_b32 s34, s34, 3
    s_mul_i32 s31, s34, 12288
    s_add_u32 s31, s31, s35
nrmp_9:
    s_waitcnt lgkmcnt(4)
    v_mfma_f32_32x32x16_bf16 v[224:239], v[52:55], v[16:19], v[224:239]
    ds_read_b64_tr_b16 v[48:49], v15 offset:6144
    v_mfma_f32_32x32x16_bf16 v[240:255], v[52:55], v[20:23], v[240:255]
    ds_read_b64_tr_b16 v[50:51], v15 offset:7680
    s_waitcnt vmcnt(7)
    s_barrier
    s_cmp_lg_u32 s32, 7
    s_cbranch_scc1 npf_10
    s_mov_b32 s4, s78
    s_mov_b32 s5, s79
    s_mov_b32 s6, s80
    s_mov_b32 s27, s81
    s_add_u32 s28, s81, 18432
npf_10:
    s_cmp_lt_u32 s32, 8
    s_cselect_b32 s82, s29, 2147418112
    s_add_u32 s29, s29, s85
    s_cmp_lt_u32 s32, 8
    s_cselect_b32 s83, s27, 2147418112
    s_cselect_b32 s84, s28, 2147418112
    s_add_u32 s27, s27, 128
    s_add_u32 s28, s28, 128
    s_waitcnt lgkmcnt(4)
    v_mfma_f32_32x32x16_bf16 v[64:79], v[56:59], v[24:27], v[64:79]
    ds_read_b64_tr_b16 v[52:53], v13 offset:55296
    s_add_u32 m0, s31, 0
    v_mfma_f32_32x32x16_bf16 v[80:95], v[56:59], v[28:31], v[80:95]
    ds_read_b64_tr_b16 v[54:55], v13 offset:56832
    buffer_load_dwordx4 v10, s[8:11], s82 offen lds
    s_waitcnt lgkmcnt(4)
    v_mfma_f32_32x32x16_bf16 v[96:111], v[60:63], v[24:27], v[96:111]
    ds_read_b64_tr_b16 v[56:57], v14 offset:55296
    s_add_u32 m0, s31, 1024
    v_mfma_f32_32x32x16_bf16 v[112:127], v[60:63], v[28:31], v[112:127]
    ds_read_b64_tr_b16 v[58:59], v14 offset:56832
    buffer_load_dwordx4 v11, s[8:11], s82 offen lds
    s_waitcnt lgkmcnt(4)
    v_mfma_f32_32x32x16_bf16 v[128:143], v[48:51], v[24:27], v[128:143]
    ds_read_b64_tr_b16 v[60:61], v15 offset:55296
    s_add_u32 m0, s31, 2048
    v_mfma_f32_32x32x16_bf16 v[144:159], v[48:51], v[28:31], v[144:159]
    ds_read_b64_tr_b16 v[62:63], v15 offset:56832
    buffer_load_dwordx4 v12, s[8:11], s82 offen lds
    s_add_u32 s34, s34, 1
    s_and_b32 s34, s34, 3
    s_mul_i32 s31, s34, 12288
    s_add_u32 s31, s31, s35
    v_add_u32 v13, 12288, v13
    v_add_u32 v14, 12288, v14
    v_add_u32 v15, 12288, v15
    s_waitcnt lgkmcnt(4)
    v_mfma_f32_32x32x16_bf16 v[160:175], v[52:55], v[24:27], v[160:175]
    ds_read_b64_tr_b16 v[48:49], v13 offset:0
    s_add_u32 m0, s30, 0
    v_mfma_f32_32x32x16_bf16 v[176:191], v[52:55], v[28:31], v[176:191]
    ds_read_b64_tr_b16 v[50:51], v13 offset:1536
    buffer_load_dwordx4 v8, s[4:7], s83 offen lds
    s_waitcnt lgkmcnt(4)
    v_mfma_f32_32x32x16_bf16 v[192:207], v[56:59], v[24:27], v[192:207]
    ds_read_b64_tr_b16 v[52:53], v14 offset:0
    s_add_u32 m0, s30, 1024
    v_mfma_f32_32x32x16_bf16 v[208:223], v[56:59], v[28:31], v[208:223]
    ds_read_b64_tr_b16 v[54:55], v14 offset:1536
    buffer_load_dwordx4 v9, s[4:7], s83 offen lds
    s_waitcnt lgkmcnt(4)
    v_mfma_f32_32x32x16_bf16 v[224:239], v[60:63], v[24:27], v[224:239]
    ds_read_b64_tr_b16 v[56:57], v15 offset:0
    s_add_u32 m0, s30, 2048
    v_mfma_f32_32x32x16_bf16 v[240:255], v[60:63], v[28:31], v[240:255]
    ds_read_b64_tr_b16 v[58:59], v15 offset:1536
    buffer_load_dwordx4 v8, s[4:7], s84 offen lds
    s_waitcnt lgkmcnt(4)
    v_mfma_f32_32x32x16_bf16 v[64:79], v[48:51], v[32:35], v[64:79]
    ds_read_b64_tr_b16 v[60:61], v13 offset:49152
    s_add_u32 m0, s30, 3072
    v_mfma_f32_32x32x16_bf16 v[80:95], v[48:51], v[36:39], v[80:95]
    ds_read_b64_tr_b16 v[62:63], v13 offset:50688
    buffer_load_dwordx4 v9, s[4:7], s84 offen lds
    s_xor_b32 s30, s30, 32768
    s_waitcnt lgkmcnt(4)
    v_mfma_f32_32x32x16_bf16 v[96:111], v[52:55], v[32:35], v[96:111]
    ds_read_b64_tr_b16 v[48:49], v14 offset:49152
    v_mfma_f32_32x32x16_bf16 v[112:127], v[52:55], v[36:39], v[112:127]
    ds_read_b64_tr_b16 v[50:51], v14 offset:50688
    s_waitcnt lgkmcnt(4)
    v_mfma_f32_32x32x16_bf16 v[128:143], v[56:59], v[32:35], v[128:143]
    ds_read_b64_tr_b16 v[52:53], v15 offset:49152
    v_mfma_f32_32x32x16_bf16 v[144:159], v[56:59], v[36:39], v[144:159]
    ds_read_b64_tr_b16 v[54:55], v15 offset:50688
    s_waitcnt lgkmcnt(4)
    v_mfma_f32_32x32x16_bf16 v[160:175], v[60:63], v[32:35], v[160:175]
    ds_read_b64_tr_b16 v[56:57], v13 offset:6144
    v_mfma_f32_32x32x16_bf16 v[176:191], v[60:63], v[36:39], v[176:191]
    ds_read_b64_tr_b16 v[58:59], v13 offset:7680
    s_waitcnt lgkmcnt(4)
    v_mfma_f32_32x32x16_bf16 v[192:207], v[48:51], v[32:35], v[192:207]
    ds_read_b64_tr_b16 v[60:61], v14 offset:6144
    v_mfma_f32_32x32x16_bf16 v[208:223], v[48:51], v[36:39], v[208:223]
    ds_read_b64_tr_b16 v[62:63], v14 offset:7680
    s_waitcnt lgkmcnt(4)
    v_mfma_f32_32x32x16_bf16 v[224:239], v[52:55], v[32:35], v[224:239]
    ds_read_b64_tr_b16 v[48:49], v15 offset:6144
    v_mfma_f32_32x32x16_bf16 v[240:255], v[52:55], v[36:39], v[240:255]
    ds_read_b64_tr_b16 v[50:51], v15 offset:7680
    s_waitcnt vmcnt(7)
    s_barrier
    s_cmp_lt_u32 s32, 7
    s_cselect_b32 s82, s29, 2147418112
    s_add_u32 s29, s29, s85
    ds_read_b128 v[16:19], v4 offset:0
    ds_read_b128 v[20:23], v4 offset:4096
    s_waitcnt lgkmcnt(6)
    v_mfma_f32_32x32x16_bf16 v[64:79], v[56:59], v[40:43], v[64:79]
    ds_read_b64_tr_b16 v[52:53], v13 offset:55296
    s_add_u32 m0, s31, 0
    v_mfma_f32_32x32x16_bf16 v[80:95], v[56:59], v[44:47], v[80:95]
    ds_read_b64_tr_b16 v[54:55], v13 offset:56832
    buffer_load_dwordx4 v10, s[8:11], s82 offen lds
    ds_read_b128 v[24:27], v5 offset:0
    ds_read_b128 v[28:31], v5 offset:4096
    s_waitcnt lgkmcnt(8)
    v_mfma_f32_32x32x16_bf16 v[96:111], v[60:63], v[40:43], v[96:111]
    ds_read_b64_tr_b16 v[56:57], v14 offset:55296
    s_add_u32 m0, s31, 1024
    v_mfma_f32_32x32x16_bf16 v[112:127], v[60:63], v[44:47], v[112:127]
    ds_read_b64_tr_b16 v[58:59], v14 offset:56832
    buffer_load_dwordx4 v11, s[8:11], s82 offen lds
    ds_read_b128 v[32:35], v6 offset:0
    ds_read_b128 v[36:39], v6 offset:4096
    s_waitcnt lgkmcnt(10)
    v_mfma_f32_32x32x16_bf16 v[128:143], v[48:51], v[40:43], v[128:143]
    ds_read_b64_tr_b16 v[60:61], v15 offset:55296
    s_add_u32 m0, s31, 2048
    v_mfma_f32_32x32x16_bf16 v[144:159], v[48:51], v[44:47], v[144:159]
    ds_read_b64_tr_b16 v[62:63], v15 offset:56832
    buffer_load_dwordx4 v12, s[8:11], s82 offen lds
    s_add_u32 s34, s34, 1
    s_and_b32 s34, s34, 3
    s_mul_i32 s31, s34, 12288
    s_add_u32 s31, s31, s35
    v_add_u32 v13, s33, v13
    v_add_u32 v14, s33, v14
    v_add_u32 v15, s33, v15
    s_sub_u32 s33, 4294942720, s33
    s_waitcnt lgkmcnt(8)
    v_mfma_f32_32x32x16_bf16 v[160:175], v[52:55], v[40:43], v[160:175]
    ds_read_b64_tr_b16 v[48:49], v13 offset:0
    v_mfma_f32_32x32x16_bf16 v[176:191], v[52:55], v[44:47], v[176:191]
    ds_read_b64_tr_b16 v[50:51], v13 offset:1536
    s_waitcnt lgkmcnt(6)
    v_mfma_f32_32x32x16_bf16 v[192:207], v[56:59], v[40:43], v[192:207]
    ds_read_b64_tr_b16 v[52:53], v14 offset:0
    v_mfma_f32_32x32x16_bf16 v[208:223], v[56:59], v[44:47], v[208:223]
    ds_read_b64_tr_b16 v[54:55], v14 offset:1536
    s_waitcnt lgkmcnt(4)
    v_mfma_f32_32x32x16_bf16 v[224:239], v[60:63], v[40:43], v[224:239]
    ds_read_b64_tr_b16 v[56:57], v15 offset:0
    v_mfma_f32_32x32x16_bf16 v[240:255], v[60:63], v[44:47], v[240:255]
    ds_read_b64_tr_b16 v[58:59], v15 offset:1536
    s_add_u32 s32, s32, 1
    s_cmp_lt_u32 s32, 9
    s_cbranch_scc1 loop_4
    s_waitcnt lgkmcnt(0)
    s_cmp_lg_u32 s24, 0
    s_cbranch_scc1 nrdy_11
    s_mov_b32 s20, s66
    s_and_b32 s21, s67, 0xffff
    s_mov_b32 s22, 256
    s_mov_b32 s23, 0x00020000
    v_mov_b32 v17, 0
    s_mov_b32 s88, 0
rdy_12:
    buffer_load_dword v16, v17, s[20:23], 0 offen sc1
    s_waitcnt vmcnt(0)
    v_readfirstlane_b32 s89, v16
    s_add_u32 s88, s88, 1
    s_cmp_ge_u32 s88, 0x40000
    s_cbranch_scc1 nrdy_11
    s_cmp_eq_u32 s89, 0
    s_cbranch_scc1 rdy_12
nrdy_11:
    s_waitcnt vmcnt(0)
    s_barrier
    s_cmp_lt_u32 s24, 4
    s_cbranch_scc1 npre_13
    v_mbcnt_lo_u32_b32 v14, -1, 0
    v_mbcnt_hi_u32_b32 v14, -1, v14
    v_add_u32 v15, 0, v14
    v_mul_u32_u24 v16, 2731, v15
    v_lshrrev_b32 v16, 16, v16
    v_mul_u32_u24 v17, 24, v16
    v_sub_u32 v15, v15, v17
    v_and_b32 v18, 3, v15
    v_lshlrev_b32 v18, 4, v18
    v_lshrrev_b32 v17, 2, v15
    v_bfe_u32 v15, v16, 1, 1
    v_xor_b32 v17, v17, v15
    v_mul_u32_u24 v10, 1152, v16
    v_lshl_add_u32 v10, v17, 6, v10
    v_add_u32 v10, v10, v18
    v_add_u32 v15, 64, v14
    v_mul_u32_u24 v16, 2731, v15
    v_lshrrev_b32 v16, 16, v16
    v_mul_u32_u24 v17, 24, v16
    v_sub_u32 v15, v15, v17
    v_and_b32 v18, 3, v15
    v_lshlrev_b32 v18, 4, v18
    v_lshrrev_b32 v17, 2, v15
    v_bfe_u32 v15, v16, 1, 1
    v_xor_b32 v17, v17, v15
    v_mul_u32_u24 v11, 1152, v16
    v_lshl_add_u32 v11, v17, 6, v11
    v_add_u32 v11, v11, v18
    v_add_u32 v15, 128, v14
    v_mul_u32_u24 v16, 2731, v15
    v_lshrrev_b32 v16, 16, v16
    v_mul_u32_u24 v17, 24, v16
    v_sub_u32 v15, v15, v17
    v_and_b32 v18, 3, v15
    v_lshlrev_b32 v18, 4, v18
    v_lshrrev_b32 v17, 2, v15
    v_bfe_u32 v15, v16, 1, 1
    v_xor_b32 v17, v17, v15
    v_mul_u32_u24 v12, 1152, v16
    v_lshl_add_u32 v12, v17, 6, v12
    v_add_u32 v12, v12, v18
    s_mov_b32 s8, s60
    s_and_b32 s9, s61, 0xffff
    s_mov_b32 s10, 5308416
    s_mov_b32 s11, 0x00020000
    s_sub_u32 s40, s24, 4
    s_mul_i32 s36, s26, 192
    s_lshl_b32 s37, s40, 4
    s_add_u32 s36, s36, s37
    s_mul_i32 s36, s36, 1152
    s_mul_i32 s37, s26, 21846
    s_lshr_b32 s37, s37, 16
    s_mul_i32 s37, s37, 3
    s_sub_u32 s37, s26, s37
    s_mul_i32 s37, s37, 384
    s_add_u32 s36, s36, s37
    s_mul_i32 s38, s40, 6144
    s_add_u32 s37, s36, 9216
    s_add_u32 m0, s38, 0
    s_nop 0
    buffer_load_dwordx4 v10, s[8:11], s36 offen lds
    s_add_u32 m0, s38, 1024
    s_nop 0
    buffer_load_dwordx4 v11, s[8:11], s36 offen lds
    s_add_u32 m0, s38, 2048
    s_nop 0
    buffer_load_dwordx4 v12, s[8:11], s36 offen lds
    s_add_u32 m0, s38, 3072
    s_nop 0
    buffer_load_dwordx4 v10, s[8:11], s37 offen lds
    s_add_u32 m0, s38, 4096
    s_nop 0
    buffer_load_dwordx4 v11, s[8:11], s37 offen lds
    s_add_u32 m0, s38, 5120
    s_nop 0
    buffer_load_dwordx4 v12, s[8:11], s37 offen lds
    s_add_u32 s36, s36, 73728
    s_add_u32 s37, s36, 9216
    s_add_u32 m0, s38, 24576
    s_nop 0
    buffer_load_dwordx4 v10, s[8:11], s36 offen lds
    s_add_u32 m0, s38, 25600
    s_nop 0
    buffer_load_dwordx4 v11, s[8:11], s36 offen lds
    s_add_u32 m0, s38, 26624
    s_nop 0
    buffer_load_dwordx4 v12, s[8:11], s36 offen lds
    s_add_u32 m0, s38, 27648
    s_nop 0
    buffer_load_dwordx4 v10, s[8:11], s37 offen lds
    s_add_u32 m0, s38, 28672
    s_nop 0
    buffer_load_dwordx4 v11, s[8:11], s37 offen lds
    s_add_u32 m0, s38, 29696
    s_nop 0
    buffer_load_dwordx4 v12, s[8:11], s37 offen lds
    s_add_u32 s36, s36, 73728
    s_add_u32 s37, s36, 9216
    s_add_u32 m0, s38, 49152
    s_nop 0
    buffer_load_dwordx4 v10, s[8:11], s36 offen lds
    s_add_u32 m0, s38, 50176
    s_nop 0
    buffer_load_dwordx4 v11, s[8:11], s36 offen lds
    s_add_u32 m0, s38, 51200
    s_nop 0
    buffer_load_dwordx4 v12, s[8:11], s36 offen lds
    s_add_u32 m0, s38, 52224
    s_nop 0
    buffer_load_dwordx4 v10, s[8:11], s37 offen lds
    s_add_u32 m0, s38, 53248
    s_nop 0
    buffer_load_dwordx4 v11, s[8:11], s37 offen lds
    s_add_u32 m0, s38, 54272
    s_nop 0
    buffer_load_dwordx4 v12, s[8:11], s37 offen lds
npre_13:
    s_mov_b32 s70, 0xc0135761
    s_mov_b32 s71, 0xc0135761
    s_mov_b32 s72, 0xbdd2d3e8
    s_mov_b32 s73, 0xbdd2d3e8
    s_and_b32 s36, s24, 3
    s_lshl_b32 s36, s36, 1
    s_lshl_b32 s37, s25, 3
    s_add_u32 s36, s36, s37
    s_mul_i32 s36, s36, 324
    s_mul_i32 s37, s26, 12
    s_add_u32 s36, s36, s37
    s_lshr_b32 s37, s24, 2
    s_mul_i32 s37, s37, 6
    s_add_u32 s36, s36, s37
    s_lshl_b32 s36, s36, 10
    s_add_u32 s37, s36, 331776
    s_add_u32 s38, s36, 4096
    s_add_u32 s39, s37, 4096
    v_mbcnt_lo_u32_b32 v14, -1, 0
    v_mbcnt_hi_u32_b32 v14, -1, v14
    v_lshlrev_b32 v1, 4, v14
    v_mov_b32 v2, 1.0
    v_mov_b32 v3, 1.0
    s_nop 7
    v_mov_b32 v62, s70
    v_mov_b32 v63, s70
    v_pk_mul_f32 v[16:17], v[64:65], v[64:65]
    v_pk_mul_f32 v[18:19], v[64:65], v[160:161]
    v_pk_mul_f32 v[20:21], v[66:67], v[66:67]
    v_pk_mul_f32 v[22:23], v[66:67], v[162:163]
    v_pk_mul_f32 v[24:25], v[68:69], v[68:69]
    v_pk_mul_f32 v[26:27], v[68:69], v[164:165]
    v_pk_mul_f32 v[28:29], v[70:71], v[70:71]
    v_pk_mul_f32 v[30:31], v[70:71], v[166:167]
    v_pk_fma_f32 v[16:17], v[16:17], s[72:73], v[62:63]
    v_pk_fma_f32 v[20:21], v[20:21], s[72:73], v[62:63]
    v_pk_fma_f32 v[24:25], v[24:25], s[72:73], v[62:63]
    v_pk_fma_f32 v[28:29], v[28:29], s[72:73], v[62:63]
    v_pk_mul_f32 v[16:17], v[16:17], v[64:65]
    v_pk_mul_f32 v[20:21], v[20:21], v[66:67]
    v_pk_mul_f32 v[24:25], v[24:25], v[68:69]
    v_pk_mul_f32 v[28:29], v[28:29], v[70:71]
    v_exp_f32 v16, v16
    v_exp_f32 v17, v17
    v_exp_f32 v20, v20
    v_exp_f32 v21, v21
    v_exp_f32 v24, v24
    v_exp_f32 v25, v25
    v_exp_f32 v28, v28
    v_exp_f32 v29, v29
    v_pk_add_f32 v[16:17], v[16:17], v[2:3]
    v_pk_add_f32 v[20:21], v[20:21], v[2:3]
    v_pk_add_f32 v[24:25], v[24:25], v[2:3]
    v_pk_add_f32 v[28:29], v[28:29], v[2:3]
    v_rcp_f32 v16, v16
    v_rcp_f32 v17, v17
    v_rcp_f32 v20, v20
    v_rcp_f32 v21, v21
    v_rcp_f32 v24, v24
    v_rcp_f32 v25, v25
    v_rcp_f32 v28, v28
    v_rcp_f32 v29, v29
    v_pk_mul_f32 v[16:17], v[16:17], v[18:19]
    v_pk_mul_f32 v[20:21], v[20:21], v[22:23]
    v_pk_mul_f32 v[24:25], v[24:25], v[26:27]
    v_pk_mul_f32 v[28:29], v[28:29], v[30:31]
    v_cvt_pk_bf16_f32 v32, v16, v17
    v_cvt_pk_bf16_f32 v33, v20, v21
    v_cvt_pk_bf16_f32 v34, v24, v25
    v_cvt_pk_bf16_f32 v35, v28, v29
    buffer_store_dwordx4 v[32:35], v1, s[12:15], s36 offen offset:0 sc1
    v_pk_mul_f32 v[36:37], v[72:73], v[72:73]
    v_pk_mul_f32 v[38:39], v[72:73], v[168:169]
    v_pk_mul_f32 v[40:41], v[74:75], v[74:75]
    v_pk_mul_f32 v[42:43], v[74:75], v[170:171]
    v_pk_mul_f32 v[44:45], v[76:77], v[76:77]
    v_pk_mul_f32 v[46:47], v[76:77], v[172:173]
    v_pk_mul_f32 v[48:49], v[78:79], v[78:79]
    v_pk_mul_f32 v[50:51], v[78:79], v[174:175]
    v_pk_fma_f32 v[36:37], v[36:37], s[72:73], v[62:63]
    v_pk_fma_f32 v[40:41], v[40:41], s[72:73], v[62:63]
    v_pk_fma_f32 v[44:45], v[44:45], s[72:73], v[62:63]
    v_pk_fma_f32 v[48:49], v[48:49], s[72:73], v[62:63]
    v_pk_mul_f32 v[36:37], v[36:37], v[72:73]
    v_pk_mul_f32 v[40:41], v[40:41], v[74:75]
    v_pk_mul_f32 v[44:45], v[44:45], v[76:77]
    v_pk_mul_f32 v[48:49], v[48:49], v[78:79]
    v_exp_f32 v36, v36
    v_exp_f32 v37, v37
    v_exp_f32 v40, v40
    v_exp_f32 v41, v41
    v_exp_f32 v44, v44
    v_exp_f32 v45, v45
    v_exp_f32 v48, v48
    v_exp_f32 v49, v49
    v_pk_add_f32 v[36:37], v[36:37], v[2:3]
    v_pk_add_f32 v[40:41], v[40:41], v[2:3]
    v_pk_add_f32 v[44:45], v[44:45], v[2:3]
    v_pk_add_f32 v[48:49], v[48:49], v[2:3]
    v_rcp_f32 v36, v36
    v_rcp_f32 v37, v37
    v_rcp_f32 v40, v40
    v_rcp_f32 v41, v41
    v_rcp_f32 v44, v44
    v_rcp_f32 v45, v45
    v_rcp_f32 v48, v48
    v_rcp_f32 v49, v49
    v_pk_mul_f32 v[36:37], v[36:37], v[38:39]
    v_pk_mul_f32 v[40:41], v[40:41], v[42:43]
    v_pk_mul_f32 v[44:45], v[44:45], v[46:47]
    v_pk_mul_f32 v[48:49], v[48:49], v[50:51]
    v_cvt_pk_bf16_f32 v52, v36, v37
    v_cvt_pk_bf16_f32 v53, v40, v41
    v_cvt_pk_bf16_f32 v54, v44, v45
    v_cvt_pk_bf16_f32 v55, v48, v49
    buffer_store_dwordx4 v[52:55], v1, s[12:15], s36 offen offset:1024 sc1
    v_pk_mul_f32 v[16:17], v[80:81], v[80:81]
    v_pk_mul_f32 v[18:19], v[80:81], v[176:177]
    v_pk_mul_f32 v[20:21], v[82:83], v[82:83]
    v_pk_mul_f32 v[22:23], v[82:83], v[178:179]
    v_pk_mul_f32 v[24:25], v[84:85], v[84:85]
    v_pk_mul_f32 v[26:27], v[84:85], v[180:181]
    v_pk_mul_f32 v[28:29], v[86:87], v[86:87]
    v_pk_mul_f32 v[30:31], v[86:87], v[182:183]
    v_pk_fma_f32 v[16:17], v[16:17], s[72:73], v[62:63]
    v_pk_fma_f32 v[20:21], v[20:21], s[72:73], v[62:63]
    v_pk_fma_f32 v[24:25], v[24:25], s[72:73], v[62:63]
    v_pk_fma_f32 v[28:29], v[28:29], s[72:73], v[62:63]
    v_pk_mul_f32 v[16:17], v[16:17], v[80:81]
    v_pk_mul_f32 v[20:21], v[20:21], v[82:83]
    v_pk_mul_f32 v[24:25], v[24:25], v[84:85]
    v_pk_mul_f32 v[28:29], v[28:29], v[86:87]
    v_exp_f32 v16, v16
    v_exp_f32 v17, v17
    v_exp_f32 v20, v20
    v_exp_f32 v21, v21
    v_exp_f32 v24, v24
    v_exp_f32 v25, v25
    v_exp_f32 v28, v28
    v_exp_f32 v29, v29
    v_pk_add_f32 v[16:17], v[16:17], v[2:3]
    v_pk_add_f32 v[20:21], v[20:21], v[2:3]
    v_pk_add_f32 v[24:25], v[24:25], v[2:3]
    v_pk_add_f32 v[28:29], v[28:29], v[2:3]
    v_rcp_f32 v16, v16
    v_rcp_f32 v17, v17
    v_rcp_f32 v20, v20
    v_rcp_f32 v21, v21
    v_rcp_f32 v24, v24
    v_rcp_f32 v25, v25
    v_rcp_f32 v28, v28
    v_rcp_f32 v29, v29
    v_pk_mul_f32 v[16:17], v[16:17], v[18:19]
    v_pk_mul_f32 v[20:21], v[20:21], v[22:23]
    v_pk_mul_f32 v[24:25], v[24:25], v[26:27]
    v_pk_mul_f32 v[28:29], v[28:29], v[30:31]
    v_cvt_pk_bf16_f32 v32, v16, v17
    v_cvt_pk_bf16_f32 v33, v20, v21
    v_cvt_pk_bf16_f32 v34, v24, v25
    v_cvt_pk_bf16_f32 v35, v28, v29
    buffer_store_dwordx4 v[32:35], v1, s[12:15], s37 offen offset:0 sc1
    v_pk_mul_f32 v[36:37], v[88:89], v[88:89]
    v_pk_mul_f32 v[38:39], v[88:89], v[184:185]
    v_pk_mul_f32 v[40:41], v[90:91], v[90:91]
    v_pk_mul_f32 v[42:43], v[90:91], v[186:187]
    v_pk_mul_f32 v[44:45], v[92:93], v[92:93]
    v_pk_mul_f32 v[46:47], v[92:93], v[188:189]
    v_pk_mul_f32 v[48:49], v[94:95], v[94:95]
    v_pk_mul_f32 v[50:51], v[94:95], v[190:191]
    v_pk_fma_f32 v[36:37], v[36:37], s[72:73], v[62:63]
    v_pk_fma_f32 v[40:41], v[40:41], s[72:73], v[62:63]
    v_pk_fma_f32 v[44:45], v[44:45], s[72:73], v[62:63]
    v_pk_fma_f32 v[48:49], v[48:49], s[72:73], v[62:63]
    v_pk_mul_f32 v[36:37], v[36:37], v[88:89]
    v_pk_mul_f32 v[40:41], v[40:41], v[90:91]
    v_pk_mul_f32 v[44:45], v[44:45], v[92:93]
    v_pk_mul_f32 v[48:49], v[48:49], v[94:95]
    v_exp_f32 v36, v36
    v_exp_f32 v37, v37
    v_exp_f32 v40, v40
    v_exp_f32 v41, v41
    v_exp_f32 v44, v44
    v_exp_f32 v45, v45
    v_exp_f32 v48, v48
    v_exp_f32 v49, v49
    v_pk_add_f32 v[36:37], v[36:37], v[2:3]
    v_pk_add_f32 v[40:41], v[40:41], v[2:3]
    v_pk_add_f32 v[44:45], v[44:45], v[2:3]
    v_pk_add_f32 v[48:49], v[48:49], v[2:3]
    v_rcp_f32 v36, v36
    v_rcp_f32 v37, v37
    v_rcp_f32 v40, v40
    v_rcp_f32 v41, v41
    v_rcp_f32 v44, v44
    v_rcp_f32 v45, v45
    v_rcp_f32 v48, v48
    v_rcp_f32 v49, v49
    v_pk_mul_f32 v[36:37], v[36:37], v[38:39]
    v_pk_mul_f32 v[40:41], v[40:41], v[42:43]
    v_pk_mul_f32 v[44:45], v[44:45], v[46:47]
    v_pk_mul_f32 v[48:49], v[48:49], v[50:51]
    v_cvt_pk_bf16_f32 v52, v36, v37
    v_cvt_pk_bf16_f32 v53, v40, v41
    v_cvt_pk_bf16_f32 v54, v44, v45
    v_cvt_pk_bf16_f32 v55, v48, v49
    buffer_store_dwordx4 v[52:55], v1, s[12:15], s37 offen offset:1024 sc1
    v_pk_mul_f32 v[16:17], v[96:97], v[96:97]
    v_pk_mul_f32 v[18:19], v[96:97], v[192:193]
    v_pk_mul_f32 v[20:21], v[98:99], v[98:99]
    v_pk_mul_f32 v[22:23], v[98:99], v[194:195]
    v_pk_mul_f32 v[24:25], v[100:101], v[100:101]
    v_pk_mul_f32 v[26:27], v[100:101], v[196:197]
    v_pk_mul_f32 v[28:29], v[102:103], v[102:103]
    v_pk_mul_f32 v[30:31], v[102:103], v[198:199]
    v_pk_fma_f32 v[16:17], v[16:17], s[72:73], v[62:63]
    v_pk_fma_f32 v[20:21], v[20:21], s[72:73], v[62:63]
    v_pk_fma_f32 v[24:25], v[24:25], s[72:73], v[62:63]
    v_pk_fma_f32 v[28:29], v[28:29], s[72:73], v[62:63]
    v_pk_mul_f32 v[16:17], v[16:17], v[96:97]
    v_pk_mul_f32 v[20:21], v[20:21], v[98:99]
    v_pk_mul_f32 v[24:25], v[24:25], v[100:101]
    v_pk_mul_f32 v[28:29], v[28:29], v[102:103]
    v_exp_f32 v16, v16
    v_exp_f32 v17, v17
    v_exp_f32 v20, v20
    v_exp_f32 v21, v21
    v_exp_f32 v24, v24
    v_exp_f32 v25, v25
    v_exp_f32 v28, v28
    v_exp_f32 v29, v29
    v_pk_add_f32 v[16:17], v[16:17], v[2:3]
    v_pk_add_f32 v[20:21], v[20:21], v[2:3]
    v_pk_add_f32 v[24:25], v[24:25], v[2:3]
    v_pk_add_f32 v[28:29], v[28:29], v[2:3]
    v_rcp_f32 v16, v16
    v_rcp_f32 v17, v17
    v_rcp_f32 v20, v20
    v_rcp_f32 v21, v21
    v_rcp_f32 v24, v24
    v_rcp_f32 v25, v25
    v_rcp_f32 v28, v28
    v_rcp_f32 v29, v29
    v_pk_mul_f32 v[16:17], v[16:17], v[18:19]
    v_pk_mul_f32 v[20:21], v[20:21], v[22:23]
    v_pk_mul_f32 v[24:25], v[24:25], v[26:27]
    v_pk_mul_f32 v[28:29], v[28:29], v[30:31]
    v_cvt_pk_bf16_f32 v32, v16, v17
    v_cvt_pk_bf16_f32 v33, v20, v21
    v_cvt_pk_bf16_f32 v34, v24, v25
    v_cvt_pk_bf16_f32 v35, v28, v29
    buffer_store_dwordx4 v[32:35], v1, s[12:15], s36 offen offset:2048 sc1
    v_pk_mul_f32 v[36:37], v[104:105], v[104:105]
    v_pk_mul_f32 v[38:39], v[104:105], v[200:201]
    v_pk_mul_f32 v[40:41], v[106:107], v[106:107]
    v_pk_mul_f32 v[42:43], v[106:107], v[202:203]
    v_pk_mul_f32 v[44:45], v[108:109], v[108:109]
    v_pk_mul_f32 v[46:47], v[108:109], v[204:205]
    v_pk_mul_f32 v[48:49], v[110:111], v[110:111]
    v_pk_mul_f32 v[50:51], v[110:111], v[206:207]
    v_pk_fma_f32 v[36:37], v[36:37], s[72:73], v[62:63]
    v_pk_fma_f32 v[40:41], v[40:41], s[72:73], v[62:63]
    v_pk_fma_f32 v[44:45], v[44:45], s[72:73], v[62:63]
    v_pk_fma_f32 v[48:49], v[48:49], s[72:73], v[62:63]
    v_pk_mul_f32 v[36:37], v[36:37], v[104:105]
    v_pk_mul_f32 v[40:41], v[40:41], v[106:107]
    v_pk_mul_f32 v[44:45], v[44:45], v[108:109]
    v_pk_mul_f32 v[48:49], v[48:49], v[110:111]
    v_exp_f32 v36, v36
    v_exp_f32 v37, v37
    v_exp_f32 v40, v40
    v_exp_f32 v41, v41
    v_exp_f32 v44, v44
    v_exp_f32 v45, v45
    v_exp_f32 v48, v48
    v_exp_f32 v49, v49
    v_pk_add_f32 v[36:37], v[36:37], v[2:3]
    v_pk_add_f32 v[40:41], v[40:41], v[2:3]
    v_pk_add_f32 v[44:45], v[44:45], v[2:3]
    v_pk_add_f32 v[48:49], v[48:49], v[2:3]
    v_rcp_f32 v36, v36
    v_rcp_f32 v37, v37
    v_rcp_f32 v40, v40
    v_rcp_f32 v41, v41
    v_rcp_f32 v44, v44
    v_rcp_f32 v45, v45
    v_rcp_f32 v48, v48
    v_rcp_f32 v49, v49
    v_pk_mul_f32 v[36:37], v[36:37], v[38:39]
    v_pk_mul_f32 v[40:41], v[40:41], v[42:43]
    v_pk_mul_f32 v[44:45], v[44:45], v[46:47]
    v_pk_mul_f32 v[48:49], v[48:49], v[50:51]
    v_cvt_pk_bf16_f32 v52, v36, v37
    v_cvt_pk_bf16_f32 v53, v40, v41
    v_cvt_pk_bf16_f32 v54, v44, v45
    v_cvt_pk_bf16_f32 v55, v48, v49
    buffer_store_dwordx4 v[52:55], v1, s[12:15], s36 offen offset:3072 sc1
    v_pk_mul_f32 v[16:17], v[112:113], v[112:113]
    v_pk_mul_f32 v[18:19], v[112:113], v[208:209]
    v_pk_mul_f32 v[20:21], v[114:115], v[114:115]
    v_pk_mul_f32 v[22:23], v[114:115], v[210:211]
    v_pk_mul_f32 v[24:25], v[116:117], v[116:117]
    v_pk_mul_f32 v[26:27], v[116:117], v[212:213]
    v_pk_mul_f32 v[28:29], v[118:119], v[118:119]
    v_pk_mul_f32 v[30:31], v[118:119], v[214:215]
    v_pk_fma_f32 v[16:17], v[16:17], s[72:73], v[62:63]
    v_pk_fma_f32 v[20:21], v[20:21], s[72:73], v[62:63]
    v_pk_fma_f32 v[24:25], v[24:25], s[72:73], v[62:63]
    v_pk_fma_f32 v[28:29], v[28:29], s[72:73], v[62:63]
    v_pk_mul_f32 v[16:17], v[16:17], v[112:113]
    v_pk_mul_f32 v[20:21], v[20:21], v[114:115]
    v_pk_mul_f32 v[24:25], v[24:25], v[116:117]
    v_pk_mul_f32 v[28:29], v[28:29], v[118:119]
    v_exp_f32 v16, v16
    v_exp_f32 v17, v17
    v_exp_f32 v20, v20
    v_exp_f32 v21, v21
    v_exp_f32 v24, v24
    v_exp_f32 v25, v25
    v_exp_f32 v28, v28
    v_exp_f32 v29, v29
    v_pk_add_f32 v[16:17], v[16:17], v[2:3]
    v_pk_add_f32 v[20:21], v[20:21], v[2:3]
    v_pk_add_f32 v[24:25], v[24:25], v[2:3]
    v_pk_add_f32 v[28:29], v[28:29], v[2:3]
    v_rcp_f32 v16, v16
    v_rcp_f32 v17, v17
    v_rcp_f32 v20, v20
    v_rcp_f32 v21, v21
    v_rcp_f32 v24, v24
    v_rcp_f32 v25, v25
    v_rcp_f32 v28, v28
    v_rcp_f32 v29, v29
    v_pk_mul_f32 v[16:17], v[16:17], v[18:19]
    v_pk_mul_f32 v[20:21], v[20:21], v[22:23]
    v_pk_mul_f32 v[24:25], v[24:25], v[26:27]
    v_pk_mul_f32 v[28:29], v[28:29], v[30:31]
    v_cvt_pk_bf16_f32 v32, v16, v17
    v_cvt_pk_bf16_f32 v33, v20, v21
    v_cvt_pk_bf16_f32 v34, v24, v25
    v_cvt_pk_bf16_f32 v35, v28, v29
    buffer_store_dwordx4 v[32:35], v1, s[12:15], s37 offen offset:2048 sc1
    v_pk_mul_f32 v[36:37], v[120:121], v[120:121]
    v_pk_mul_f32 v[38:39], v[120:121], v[216:217]
    v_pk_mul_f32 v[40:41], v[122:123], v[122:123]
    v_pk_mul_f32 v[42:43], v[122:123], v[218:219]
    v_pk_mul_f32 v[44:45], v[124:125], v[124:125]
    v_pk_mul_f32 v[46:47], v[124:125], v[220:221]
    v_pk_mul_f32 v[48:49], v[126:127], v[126:127]
    v_pk_mul_f32 v[50:51], v[126:127], v[222:223]
    v_pk_fma_f32 v[36:37], v[36:37], s[72:73], v[62:63]
    v_pk_fma_f32 v[40:41], v[40:41], s[72:73], v[62:63]
    v_pk_fma_f32 v[44:45], v[44:45], s[72:73], v[62:63]
    v_pk_fma_f32 v[48:49], v[48:49], s[72:73], v[62:63]
    v_pk_mul_f32 v[36:37], v[36:37], v[120:121]
    v_pk_mul_f32 v[40:41], v[40:41], v[122:123]
    v_pk_mul_f32 v[44:45], v[44:45], v[124:125]
    v_pk_mul_f32 v[48:49], v[48:49], v[126:127]
    v_exp_f32 v36, v36
    v_exp_f32 v37, v37
    v_exp_f32 v40, v40
    v_exp_f32 v41, v41
    v_exp_f32 v44, v44
    v_exp_f32 v45, v45
    v_exp_f32 v48, v48
    v_exp_f32 v49, v49
    v_pk_add_f32 v[36:37], v[36:37], v[2:3]
    v_pk_add_f32 v[40:41], v[40:41], v[2:3]
    v_pk_add_f32 v[44:45], v[44:45], v[2:3]
    v_pk_add_f32 v[48:49], v[48:49], v[2:3]
    v_rcp_f32 v36, v36
    v_rcp_f32 v37, v37
    v_rcp_f32 v40, v40
    v_rcp_f32 v41, v41
    v_rcp_f32 v44, v44
    v_rcp_f32 v45, v45
    v_rcp_f32 v48, v48
    v_rcp_f32 v49, v49
    v_pk_mul_f32 v[36:37], v[36:37], v[38:39]
    v_pk_mul_f32 v[40:41], v[40:41], v[42:43]
    v_pk_mul_f32 v[44:45], v[44:45], v[46:47]
    v_pk_mul_f32 v[48:49], v[48:49], v[50:51]
    v_cvt_pk_bf16_f32 v52, v36, v37
    v_cvt_pk_bf16_f32 v53, v40, v41
    v_cvt_pk_bf16_f32 v54, v44, v45
    v_cvt_pk_bf16_f32 v55, v48, v49
    buffer_store_dwordx4 v[52:55], v1, s[12:15], s37 offen offset:3072 sc1
    v_pk_mul_f32 v[16:17], v[128:129], v[128:129]
    v_pk_mul_f32 v[18:19], v[128:129], v[224:225]
    v_pk_mul_f32 v[20:21], v[130:131], v[130:131]
    v_pk_mul_f32 v[22:23], v[130:131], v[226:227]
    v_pk_mul_f32 v[24:25], v[132:133], v[132:133]
    v_pk_mul_f32 v[26:27], v[132:133], v[228:229]
    v_pk_mul_f32 v[28:29], v[134:135], v[134:135]
    v_pk_mul_f32 v[30:31], v[134:135], v[230:231]
    v_pk_fma_f32 v[16:17], v[16:17], s[72:73], v[62:63]
    v_pk_fma_f32 v[20:21], v[20:21], s[72:73], v[62:63]
    v_pk_fma_f32 v[24:25], v[24:25], s[72:73], v[62:63]
    v_pk_fma_f32 v[28:29], v[28:29], s[72:73], v[62:63]
    v_pk_mul_f32 v[16:17], v[16:17], v[128:129]
    v_pk_mul_f32 v[20:21], v[20:21], v[130:131]
    v_pk_mul_f32 v[24:25], v[24:25], v[132:133]
    v_pk_mul_f32 v[28:29], v[28:29], v[134:135]
    v_exp_f32 v16, v16
    v_exp_f32 v17, v17
    v_exp_f32 v20, v20
    v_exp_f32 v21, v21
    v_exp_f32 v24, v24
    v_exp_f32 v25, v25
    v_exp_f32 v28, v28
    v_exp_f32 v29, v29
    v_pk_add_f32 v[16:17], v[16:17], v[2:3]
    v_pk_add_f32 v[20:21], v[20:21], v[2:3]
    v_pk_add_f32 v[24:25], v[24:25], v[2:3]
    v_pk_add_f32 v[28:29], v[28:29], v[2:3]
    v_rcp_f32 v16, v16
    v_rcp_f32 v17, v17
    v_rcp_f32 v20, v20
    v_rcp_f32 v21, v21
    v_rcp_f32 v24, v24
    v_rcp_f32 v25, v25
    v_rcp_f32 v28, v28
    v_rcp_f32 v29, v29
    v_pk_mul_f32 v[16:17], v[16:17], v[18:19]
    v_pk_mul_f32 v[20:21], v[20:21], v[22:23]
    v_pk_mul_f32 v[24:25], v[24:25], v[26:27]
    v_pk_mul_f32 v[28:29], v[28:29], v[30:31]
    v_cvt_pk_bf16_f32 v32, v16, v17
    v_cvt_pk_bf16_f32 v33, v20, v21
    v_cvt_pk_bf16_f32 v34, v24, v25
    v_cvt_pk_bf16_f32 v35, v28, v29
    buffer_store_dwordx4 v[32:35], v1, s[12:15], s38 offen offset:0 sc1
    v_pk_mul_f32 v[36:37], v[136:137], v[136:137]
    v_pk_mul_f32 v[38:39], v[136:137], v[232:233]
    v_pk_mul_f32 v[40:41], v[138:139], v[138:139]
    v_pk_mul_f32 v[42:43], v[138:139], v[234:235]
    v_pk_mul_f32 v[44:45], v[140:141], v[140:141]
    v_pk_mul_f32 v[46:47], v[140:141], v[236:237]
    v_pk_mul_f32 v[48:49], v[142:143], v[142:143]
    v_pk_mul_f32 v[50:51], v[142:143], v[238:239]
    v_pk_fma_f32 v[36:37], v[36:37], s[72:73], v[62:63]
    v_pk_fma_f32 v[40:41], v[40:41], s[72:73], v[62:63]
    v_pk_fma_f32 v[44:45], v[44:45], s[72:73], v[62:63]
    v_pk_fma_f32 v[48:49], v[48:49], s[72:73], v[62:63]
    v_pk_mul_f32 v[36:37], v[36:37], v[136:137]
    v_pk_mul_f32 v[40:41], v[40:41], v[138:139]
    v_pk_mul_f32 v[44:45], v[44:45], v[140:141]
    v_pk_mul_f32 v[48:49], v[48:49], v[142:143]
    v_exp_f32 v36, v36
    v_exp_f32 v37, v37
    v_exp_f32 v40, v40
    v_exp_f32 v41, v41
    v_exp_f32 v44, v44
    v_exp_f32 v45, v45
    v_exp_f32 v48, v48
    v_exp_f32 v49, v49
    v_pk_add_f32 v[36:37], v[36:37], v[2:3]
    v_pk_add_f32 v[40:41], v[40:41], v[2:3]
    v_pk_add_f32 v[44:45], v[44:45], v[2:3]
    v_pk_add_f32 v[48:49], v[48:49], v[2:3]
    v_rcp_f32 v36, v36
    v_rcp_f32 v37, v37
    v_rcp_f32 v40, v40
    v_rcp_f32 v41, v41
    v_rcp_f32 v44, v44
    v_rcp_f32 v45, v45
    v_rcp_f32 v48, v48
    v_rcp_f32 v49, v49
    v_pk_mul_f32 v[36:37], v[36:37], v[38:39]
    v_pk_mul_f32 v[40:41], v[40:41], v[42:43]
    v_pk_mul_f32 v[44:45], v[44:45], v[46:47]
    v_pk_mul_f32 v[48:49], v[48:49], v[50:51]
    v_cvt_pk_bf16_f32 v52, v36, v37
    v_cvt_pk_bf16_f32 v53, v40, v41
    v_cvt_pk_bf16_f32 v54, v44, v45
    v_cvt_pk_bf16_f32 v55, v48, v49
    buffer_store_dwordx4 v[52:55], v1, s[12:15], s38 offen offset:1024 sc1
    v_pk_mul_f32 v[16:17], v[144:145], v[144:145]
    v_pk_mul_f32 v[18:19], v[144:145], v[240:241]
    v_pk_mul_f32 v[20:21], v[146:147], v[146:147]
    v_pk_mul_f32 v[22:23], v[146:147], v[242:243]
    v_pk_mul_f32 v[24:25], v[148:149], v[148:149]
    v_pk_mul_f32 v[26:27], v[148:149], v[244:245]
    v_pk_mul_f32 v[28:29], v[150:151], v[150:151]
    v_pk_mul_f32 v[30:31], v[150:151], v[246:247]
    v_pk_fma_f32 v[16:17], v[16:17], s[72:73], v[62:63]
    v_pk_fma_f32 v[20:21], v[20:21], s[72:73], v[62:63]
    v_pk_fma_f32 v[24:25], v[24:25], s[72:73], v[62:63]
    v_pk_fma_f32 v[28:29], v[28:29], s[72:73], v[62:63]
    v_pk_mul_f32 v[16:17], v[16:17], v[144:145]
    v_pk_mul_f32 v[20:21], v[20:21], v[146:147]
    v_pk_mul_f32 v[24:25], v[24:25], v[148:149]
    v_pk_mul_f32 v[28:29], v[28:29], v[150:151]
    v_exp_f32 v16, v16
    v_exp_f32 v17, v17
    v_exp_f32 v20, v20
    v_exp_f32 v21, v21
    v_exp_f32 v24, v24
    v_exp_f32 v25, v25
    v_exp_f32 v28, v28
    v_exp_f32 v29, v29
    v_pk_add_f32 v[16:17], v[16:17], v[2:3]
    v_pk_add_f32 v[20:21], v[20:21], v[2:3]
    v_pk_add_f32 v[24:25], v[24:25], v[2:3]
    v_pk_add_f32 v[28:29], v[28:29], v[2:3]
    v_rcp_f32 v16, v16
    v_rcp_f32 v17, v17
    v_rcp_f32 v20, v20
    v_rcp_f32 v21, v21
    v_rcp_f32 v24, v24
    v_rcp_f32 v25, v25
    v_rcp_f32 v28, v28
    v_rcp_f32 v29, v29
    v_pk_mul_f32 v[16:17], v[16:17], v[18:19]
    v_pk_mul_f32 v[20:21], v[20:21], v[22:23]
    v_pk_mul_f32 v[24:25], v[24:25], v[26:27]
    v_pk_mul_f32 v[28:29], v[28:29], v[30:31]
    v_cvt_pk_bf16_f32 v32, v16, v17
    v_cvt_pk_bf16_f32 v33, v20, v21
    v_cvt_pk_bf16_f32 v34, v24, v25
    v_cvt_pk_bf16_f32 v35, v28, v29
    buffer_store_dwordx4 v[32:35], v1, s[12:15], s39 offen offset:0 sc1
    v_pk_mul_f32 v[36:37], v[152:153], v[152:153]
    v_pk_mul_f32 v[38:39], v[152:153], v[248:249]
    v_pk_mul_f32 v[40:41], v[154:155], v[154:155]
    v_pk_mul_f32 v[42:43], v[154:155], v[250:251]
    v_pk_mul_f32 v[44:45], v[156:157], v[156:157]
    v_pk_mul_f32 v[46:47], v[156:157], v[252:253]
    v_pk_mul_f32 v[48:49], v[158:159], v[158:159]
    v_pk_mul_f32 v[50:51], v[158:159], v[254:255]
    v_pk_fma_f32 v[36:37], v[36:37], s[72:73], v[62:63]
    v_pk_fma_f32 v[40:41], v[40:41], s[72:73], v[62:63]
    v_pk_fma_f32 v[44:45], v[44:45], s[72:73], v[62:63]
    v_pk_fma_f32 v[48:49], v[48:49], s[72:73], v[62:63]
    v_pk_mul_f32 v[36:37], v[36:37], v[152:153]
    v_pk_mul_f32 v[40:41], v[40:41], v[154:155]
    v_pk_mul_f32 v[44:45], v[44:45], v[156:157]
    v_pk_mul_f32 v[48:49], v[48:49], v[158:159]
    v_exp_f32 v36, v36
    v_exp_f32 v37, v37
    v_exp_f32 v40, v40
    v_exp_f32 v41, v41
    v_exp_f32 v44, v44
    v_exp_f32 v45, v45
    v_exp_f32 v48, v48
    v_exp_f32 v49, v49
    v_pk_add_f32 v[36:37], v[36:37], v[2:3]
    v_pk_add_f32 v[40:41], v[40:41], v[2:3]
    v_pk_add_f32 v[44:45], v[44:45], v[2:3]
    v_pk_add_f32 v[48:49], v[48:49], v[2:3]
    v_rcp_f32 v36, v36
    v_rcp_f32 v37, v37
    v_rcp_f32 v40, v40
    v_rcp_f32 v41, v41
    v_rcp_f32 v44, v44
    v_rcp_f32 v45, v45
    v_rcp_f32 v48, v48
    v_rcp_f32 v49, v49
    v_pk_mul_f32 v[36:37], v[36:37], v[38:39]
    v_pk_mul_f32 v[40:41], v[40:41], v[42:43]
    v_pk_mul_f32 v[44:45], v[44:45], v[46:47]
    v_pk_mul_f32 v[48:49], v[48:49], v[50:51]
    v_cvt_pk_bf16_f32 v52, v36, v37
    v_cvt_pk_bf16_f32 v53, v40, v41
    v_cvt_pk_bf16_f32 v54, v44, v45
    v_cvt_pk_bf16_f32 v55, v48, v49
    buffer_store_dwordx4 v[52:55], v1, s[12:15], s39 offen offset:1024 sc1
    s_waitcnt vmcnt(0) lgkmcnt(0)
    s_barrier
    s_cmp_lg_u32 s24, 0
    s_cbranch_scc1 nsig_14
    s_lshl_b32 s36, s25, 7
    s_add_u32 s36, s36, 45154304
    v_mov_b32 v16, 1
    v_mov_b32 v17, 0
    s_mov_b64 exec, 1
    buffer_atomic_add v16, v17, s[12:15], s36 offen offset:0
    s_mov_b64 exec, -1
nsig_14:
    s_branch k2_entry
k1_qkv:
    s_mov_b32 s25, s37
    s_mov_b32 s26, s36
    s_mov_b32 s8, s50
    s_and_b32 s9, s51, 0xffff
    s_mov_b32 s10, 1990656
    s_mov_b32 s11, 0x00020000
    s_mov_b32 s16, s62
    s_and_b32 s17, s63, 0xffff
    s_mov_b32 s18, 1152
    s_mov_b32 s19, 0x00020000
    v_lshlrev_b32 v15, 4, v0
    buffer_load_dwordx4 v[20:23], v15, s[16:19], 0 offen
    s_mov_b32 s70, 0x3fb8aa3b
    s_mov_b32 s71, 0x3fb8aa3b
    s_mov_b32 s72, 0x358637bd
    s_mov_b32 s73, 0x358637bd
    s_lshl_b32 s36, s25, 8
    s_lshl_b32 s37, s24, 5
    s_add_u32 s36, s36, s37
    s_mul_i32 s27, s36, 1152
    s_add_u32 s28, s27, 18432
    s_lshl_b32 s30, s24, 12
    s_and_b32 s36, s24, 3
    s_mul_i32 s29, s36, 27648
    s_mul_i32 s37, s26, 144
    s_add_u32 s29, s29, s37
    s_cmp_lt_u32 s24, 4
    s_cselect_b32 s38, 0, 2304
    s_cselect_b32 s39, 6, 3
    s_add_u32 s29, s29, s38
    s_mov_b32 s85, 110592
    v_add_u32 v15, 0, v14
    v_mul_u32_u24 v16, 2731, v15
    v_lshrrev_b32 v16, 16, v16
    v_mul_u32_u24 v17, 24, v16
    v_sub_u32 v15, v15, v17
    v_and_b32 v18, 3, v15
    v_lshlrev_b32 v18, 4, v18
    v_lshrrev_b32 v17, 2, v15
    v_bfe_u32 v15, v16, 1, 1
    v_xor_b32 v17, v17, v15
    v_mul_u32_u24 v10, 3456, v16
    v_lshl_add_u32 v10, v17, 6, v10
    v_add_u32 v10, v10, v18
    v_cmp_lt_u32 vcc, 2, v17
    v_mov_b32 v15, 960
    v_cmp_gt_u32 s[42:43], s39, v17
    v_cndmask_b32 v15, 0, v15, vcc
    v_add_u32 v10, v10, v15
    v_add_u32 v15, 64, v14
    v_mul_u32_u24 v16, 2731, v15
    v_lshrrev_b32 v16, 16, v16
    v_mul_u32_u24 v17, 24, v16
    v_sub_u32 v15, v15, v17
    v_and_b32 v18, 3, v15
    v_lshlrev_b32 v18, 4, v18
    v_lshrrev_b32 v17, 2, v15
    v_bfe_u32 v15, v16, 1, 1
    v_xor_b32 v17, v17, v15
    v_mul_u32_u24 v11, 3456, v16
    v_lshl_add_u32 v11, v17, 6, v11
    v_add_u32 v11, v11, v18
    v_cmp_lt_u32 vcc, 2, v17
    v_mov_b32 v15, 960
    v_cmp_gt_u32 s[44:45], s39, v17
    v_cndmask_b32 v15, 0, v15, vcc
    v_add_u32 v11, v11, v15
    v_add_u32 v15, 128, v14
    v_mul_u32_u24 v16, 2731, v15
    v_lshrrev_b32 v16, 16, v16
    v_mul_u32_u24 v17, 24, v16
    v_sub_u32 v15, v15, v17
    v_and_b32 v18, 3, v15
    v_lshlrev_b32 v18, 4, v18
    v_lshrrev_b32 v17, 2, v15
    v_bfe_u32 v15, v16, 1, 1
    v_xor_b32 v17, v17, v15
    v_mul_u32_u24 v12, 3456, v16
    v_lshl_add_u32 v12, v17, 6, v12
    v_add_u32 v12, v12, v18
    v_cmp_lt_u32 vcc, 2, v17
    v_mov_b32 v15, 960
    v_cmp_gt_u32 s[46:47], s39, v17
    v_cndmask_b32 v15, 0, v15, vcc
    v_add_u32 v12, v12, v15
    s_and_b32 s36, s24, 3
    s_mul_i32 s35, s36, 3072
    s_cmp_lt_u32 s24, 4
    s_cselect_b32 s37, 0, 49152
    s_add_u32 s35, s35, s37
    s_add_u32 s35, s35, 65536
    s_mov_b32 s31, s35
    s_mov_b32 s34, 0
    s_mov_b32 s33, 12288
    s_mov_b32 s83, s27
    s_mov_b32 s84, s28
    s_add_u32 s27, s27, 128
    s_add_u32 s28, s28, 128
    s_add_u32 m0, s30, 0
    s_nop 0
    buffer_load_dwordx4 v8, s[4:7], s83 offen lds
    s_add_u32 m0, s30, 1024
    s_nop 0
    buffer_load_dwordx4 v9, s[4:7], s83 offen lds
    s_add_u32 m0, s30, 2048
    s_nop 0
    buffer_load_dwordx4 v8, s[4:7], s84 offen lds
    s_add_u32 m0, s30, 3072
    s_nop 0
    buffer_load_dwordx4 v9, s[4:7], s84 offen lds
    s_xor_b32 s30, s30, 32768
    s_mov_b32 s82, s29
    s_add_u32 s29, s29, s85
    s_add_u32 m0, s31, 0
    s_nop 0
    s_mov_b64 exec, s[42:43]
    buffer_load_dwordx4 v10, s[8:11], s82 offen lds
    s_mov_b64 exec, -1
    s_add_u32 m0, s31, 1024
    s_nop 0
    s_mov_b64 exec, s[44:45]
    buffer_load_dwordx4 v11, s[8:11], s82 offen lds
    s_mov_b64 exec, -1
    s_add_u32 m0, s31, 2048
    s_nop 0
    s_mov_b64 exec, s[46:47]
    buffer_load_dwordx4 v12, s[8:11], s82 offen lds
    s_mov_b64 exec, -1
    s_add_u32 s34, s34, 1
    s_and_b32 s34, s34, 3
    s_mul_i32 s31, s34, 12288
    s_add_u32 s31, s31, s35
    s_and_b32 s36, s24, 3
    s_lshl_b32 s36, s36, 6
    v_and_b32 v15, 31, v14
    v_add_u32 v15, s36, v15
    v_lshlrev_b32 v4, 7, v15
    v_bfe_u32 v15, v14, 1, 3
    v_lshrrev_b32 v13, 5, v14
    v_xor_b32 v15, v15, v13
    v_lshl_add_u32 v4, v15, 4, v4
    v_xor_b32 v5, 32, v4
    v_xor_b32 v6, 64, v4
    v_xor_b32 v7, 96, v4
    v_lshrrev_b32 v15, 5, v14
    v_lshlrev_b32 v16, 3, v15
    v_bfe_u32 v15, v14, 2, 2
    v_add_u32 v16, v16, v15
    v_mul_u32_u24 v16, 384, v16
    v_lshrrev_b32 v17, 1, v15
    v_bfe_u32 v15, v14, 4, 1
    v_lshl_add_u32 v16, v15, 5, v16
    v_and_b32 v15, 3, v14
    v_lshl_add_u32 v16, v15, 3, v16
    v_add_u32 v16, 65536, v16
    v_xor_b32 v15, 0, v17
    v_lshl_add_u32 v1, v15, 6, v16
    v_xor_b32 v15, 1, v17
    v_lshl_add_u32 v2, v15, 6, v16
    v_lshrrev_b32 v15, 3, v0
    v_mul_u32_u24 v15, 384, v15
    v_and_b32 v13, 7, v0
    v_lshl_add_u32 v15, v13, 4, v15
    v_add_u32 v15, 114944, v15
    s_waitcnt vmcnt(7)
    v_cmp_gt_u32 vcc, 72, v0
    s_and_saveexec_b64 s[36:37], vcc
    s_cbranch_execz ngw_15
    ds_write_b128 v15, v[20:23]
ngw_15:
    s_mov_b64 exec, -1
    v_lshrrev_b32 v13, 5, v14
    v_lshlrev_b32 v13, 4, v13
    v_add_u32 v13, 114944, v13
    v_mov_b32 v80, 0
    v_mov_b32 v81, 0
    v_mov_b32 v82, 0
    v_mov_b32 v83, 0
    v_mov_b32 v84, 0
    v_mov_b32 v85, 0
    v_mov_b32 v86, 0
    v_mov_b32 v87, 0
    v_mov_b32 v88, 0
    v_mov_b32 v89, 0
    v_mov_b32 v90, 0
    v_mov_b32 v91, 0
    v_mov_b32 v92, 0
    v_mov_b32 v93, 0
    v_mov_b32 v94, 0
    v_mov_b32 v95, 0
    v_mov_b32 v96, 0
    v_mov_b32 v97, 0
    v_mov_b32 v98, 0
    v_mov_b32 v99, 0
    v_mov_b32 v100, 0
    v_mov_b32 v101, 0
    v_mov_b32 v102, 0
    v_mov_b32 v103, 0
    v_mov_b32 v104, 0
    v_mov_b32 v105, 0
    v_mov_b32 v106, 0
    v_mov_b32 v107, 0
    v_mov_b32 v108, 0
    v_mov_b32 v109, 0
    v_mov_b32 v110, 0
    v_mov_b32 v111, 0
    v_mov_b32 v112, 0
    v_mov_b32 v113, 0
    v_mov_b32 v114, 0
    v_mov_b32 v115, 0
    v_mov_b32 v116, 0
    v_mov_b32 v117, 0
    v_mov_b32 v118, 0
    v_mov_b32 v119, 0
    v_mov_b32 v120, 0
    v_mov_b32 v121, 0
    v_mov_b32 v122, 0
    v_mov_b32 v123, 0
    v_mov_b32 v124, 0
    v_mov_b32 v125, 0
    v_mov_b32 v126, 0
    v_mov_b32 v127, 0
    v_mov_b32 v128, 0
    v_mov_b32 v129, 0
    v_mov_b32 v130, 0
    v_mov_b32 v131, 0
    v_mov_b32 v132, 0
    v_mov_b32 v133, 0
    v_mov_b32 v134, 0
    v_mov_b32 v135, 0
    v_mov_b32 v136, 0
    v_mov_b32 v137, 0
    v_mov_b32 v138, 0
    v_mov_b32 v139, 0
    v_mov_b32 v140, 0
    v_mov_b32 v141, 0
    v_mov_b32 v142, 0
    v_mov_b32 v143, 0
    v_mov_b32 v144, 0
    v_mov_b32 v145, 0
    v_mov_b32 v146, 0
    v_mov_b32 v147, 0
    v_mov_b32 v148, 0
    v_mov_b32 v149, 0
    v_mov_b32 v150, 0
    v_mov_b32 v151, 0
    v_mov_b32 v152, 0
    v_mov_b32 v153, 0
    v_mov_b32 v154, 0
    v_mov_b32 v155, 0
    v_mov_b32 v156, 0
    v_mov_b32 v157, 0
    v_mov_b32 v158, 0
    v_mov_b32 v159, 0
    v_mov_b32 v160, 0
    v_mov_b32 v161, 0
    v_mov_b32 v162, 0
    v_mov_b32 v163, 0
    v_mov_b32 v164, 0
    v_mov_b32 v165, 0
    v_mov_b32 v166, 0
    v_mov_b32 v167, 0
    v_mov_b32 v168, 0
    v_mov_b32 v169, 0
    v_mov_b32 v170, 0
    v_mov_b32 v171, 0
    v_mov_b32 v172, 0
    v_mov_b32 v173, 0
    v_mov_b32 v174, 0
    v_mov_b32 v175, 0
    v_mov_b32 v176, 0
    v_mov_b32 v177, 0
    v_mov_b32 v178, 0
    v_mov_b32 v179, 0
    v_mov_b32 v180, 0
    v_mov_b32 v181, 0
    v_mov_b32 v182, 0
    v_mov_b32 v183, 0
    v_mov_b32 v184, 0
    v_mov_b32 v185, 0
    v_mov_b32 v186, 0
    v_mov_b32 v187, 0
    v_mov_b32 v188, 0
    v_mov_b32 v189, 0
    v_mov_b32 v190, 0
    v_mov_b32 v191, 0
    v_mov_b32 v192, 0
    v_mov_b32 v193, 0
    v_mov_b32 v194, 0
    v_mov_b32 v195, 0
    v_mov_b32 v196, 0
    v_mov_b32 v197, 0
    v_mov_b32 v198, 0
    v_mov_b32 v199, 0
    v_mov_b32 v200, 0
    v_mov_b32 v201, 0
    v_mov_b32 v202, 0
    v_mov_b32 v203, 0
    v_mov_b32 v204, 0
    v_mov_b32 v205, 0
    v_mov_b32 v206, 0
    v_mov_b32 v207, 0
    v_mov_b32 v208, 0
    v_mov_b32 v209, 0
    v_mov_b32 v210, 0
    v_mov_b32 v211, 0
    v_mov_b32 v212, 0
    v_mov_b32 v213, 0
    v_mov_b32 v214, 0
    v_mov_b32 v215, 0
    v_mov_b32 v216, 0
    v_mov_b32 v217, 0
    v_mov_b32 v218, 0
    v_mov_b32 v219, 0
    v_mov_b32 v220, 0
    v_mov_b32 v221, 0
    v_mov_b32 v222, 0
    v_mov_b32 v223, 0
    v_mov_b32 v224, 0
    v_mov_b32 v225, 0
    v_mov_b32 v226, 0
    v_mov_b32 v227, 0
    v_mov_b32 v228, 0
    v_mov_b32 v229, 0
    v_mov_b32 v230, 0
    v_mov_b32 v231, 0
    v_mov_b32 v232, 0
    v_mov_b32 v233, 0
    v_mov_b32 v234, 0
    v_mov_b32 v235, 0
    v_mov_b32 v236, 0
    v_mov_b32 v237, 0
    v_mov_b32 v238, 0
    v_mov_b32 v239, 0
    v_mov_b32 v72, 0
    s_lshr_b32 s36, s26, 1
    s_and_b32 s86, s26, 1
    s_add_u32 s86, s86, 1
    s_cmp_eq_u32 s36, s24
    s_cselect_b32 s86, s86, 0
    s_mov_b32 s82, s29
    s_add_u32 s29, s29, s85
    s_add_u32 m0, s31, 0
    s_nop 0
    s_mov_b64 exec, s[42:43]
    buffer_load_dwordx4 v10, s[8:11], s82 offen lds
    s_mov_b64 exec, -1
    s_add_u32 m0, s31, 1024
    s_nop 0
    s_mov_b64 exec, s[44:45]
    buffer_load_dwordx4 v11, s[8:11], s82 offen lds
    s_mov_b64 exec, -1
    s_add_u32 m0, s31, 2048
    s_nop 0
    s_mov_b64 exec, s[46:47]
    buffer_load_dwordx4 v12, s[8:11], s82 offen lds
    s_mov_b64 exec, -1
    s_add_u32 s34, s34, 1
    s_and_b32 s34, s34, 3
    s_mul_i32 s31, s34, 12288
    s_add_u32 s31, s31, s35
    s_waitcnt vmcnt(3) lgkmcnt(0)
    s_barrier
    s_cmp_ge_u32 s24, 4
    s_cbranch_scc1 cg1_16
    ds_read_b128 v[16:19], v4 offset:0
    ds_read_b128 v[20:23], v4 offset:4096
    ds_read_b128 v[24:27], v5 offset:0
    ds_read_b128 v[28:31], v5 offset:4096
    ds_read_b128 v[32:35], v6 offset:0
    ds_read_b128 v[36:39], v6 offset:4096
    ds_read_b128 v[64:67], v13 offset:0
    s_waitcnt lgkmcnt(0)
    ds_read_b64_tr_b16 v[48:49], v1 offset:0
    ds_read_b64_tr_b16 v[50:51], v1 offset:1536
    ds_read_b64_tr_b16 v[52:53], v2 offset:0
    ds_read_b64_tr_b16 v[54:55], v2 offset:1536
    ds_read_b64_tr_b16 v[56:57], v1 offset:128
    ds_read_b64_tr_b16 v[58:59], v1 offset:1664
    s_mov_b32 s32, 0
loop_18:
    ds_read_b128 v[40:43], v7 offset:0
    ds_read_b128 v[44:47], v7 offset:4096
    v_xor_b32 v4, 32768, v4
    v_xor_b32 v5, 32768, v5
    v_xor_b32 v6, 32768, v6
    v_xor_b32 v7, 32768, v7
    ds_read_b128 v[68:71], v13 offset:32
    s_waitcnt lgkmcnt(7)
    v_mfma_f32_32x32x16_bf16 v[80:95], v[48:51], v[16:19], v[80:95]
    ds_read_b64_tr_b16 v[60:61], v2 offset:128
    v_mfma_f32_32x32x16_bf16 v[96:111], v[48:51], v[20:23], v[96:111]
    ds_read_b64_tr_b16 v[62:63], v2 offset:1664
    s_cmp_eq_u32 s86, 0
    s_cbranch_scc1 nodot_19
    s_cmp_eq_u32 s86, 2
    s_cbranch_scc1 dot1_20
    v_dot2c_f32_bf16 v72, v16, v64
    v_dot2c_f32_bf16 v72, v17, v65
    v_dot2c_f32_bf16 v72, v18, v66
    v_dot2c_f32_bf16 v72, v19, v67
    s_branch nodot_19
dot1_20:
    v_dot2c_f32_bf16 v72, v20, v64
    v_dot2c_f32_bf16 v72, v21, v65
    v_dot2c_f32_bf16 v72, v22, v66
    v_dot2c_f32_bf16 v72, v23, v67
nodot_19:
    s_cmp_lg_u32 s32, 0
    s_cbranch_scc1 nrmp_21
    s_mov_b32 s83, s27
    s_mov_b32 s84, s28
    s_add_u32 s27, s27, 128
    s_add_u32 s28, s28, 128
    s_add_u32 m0, s30, 0
    s_nop 0
    buffer_load_dwordx4 v8, s[4:7], s83 offen lds
    s_add_u32 m0, s30, 1024
    s_nop 0
    buffer_load_dwordx4 v9, s[4:7], s83 offen lds
    s_add_u32 m0, s30, 2048
    s_nop 0
    buffer_load_dwordx4 v8, s[4:7], s84 offen lds
nrmp_21:
    s_waitcnt lgkmcnt(7)
    v_mfma_f32_32x32x16_bf16 v[112:127], v[52:55], v[16:19], v[112:127]
    ds_read_b64_tr_b16 v[48:49], v1 offset:6144
    v_mfma_f32_32x32x16_bf16 v[128:143], v[52:55], v[20:23], v[128:143]
    ds_read_b64_tr_b16 v[50:51], v1 offset:7680
    s_cmp_lg_u32 s32, 0
    s_cbranch_scc1 nrmp_22
    s_add_u32 m0, s30, 3072
    s_nop 0
    buffer_load_dwordx4 v9, s[4:7], s84 offen lds
    s_xor_b32 s30, s30, 32768
    s_mov_b32 s82, s29
    s_add_u32 s29, s29, s85
    s_add_u32 m0, s31, 0
    s_nop 0
    s_mov_b64 exec, s[42:43]
    buffer_load_dwordx4 v10, s[8:11], s82 offen lds
    s_mov_b64 exec, -1
nrmp_22:
    s_waitcnt lgkmcnt(7)
    v_mfma_f32_32x32x16_bf16 v[144:159], v[56:59], v[16:19], v[144:159]
    ds_read_b64_tr_b16 v[52:53], v2 offset:6144
    v_mfma_f32_32x32x16_bf16 v[160:175], v[56:59], v[20:23], v[160:175]
    ds_read_b64_tr_b16 v[54:55], v2 offset:7680
    s_cmp_lg_u32 s32, 0
    s_cbranch_scc1 nrmp_23
    s_add_u32 m0, s31, 1024
    s_nop 0
    s_mov_b64 exec, s[44:45]
    buffer_load_dwordx4 v11, s[8:11], s82 offen lds
    s_mov_b64 exec, -1
    s_add_u32 m0, s31, 2048
    s_nop 0
    s_mov_b64 exec, s[46:47]
    buffer_load_dwordx4 v12, s[8:11], s82 offen lds
    s_mov_b64 exec, -1
    s_add_u32 s34, s34, 1
    s_and_b32 s34, s34, 3
    s_mul_i32 s31, s34, 12288
    s_add_u32 s31, s31, s35
nrmp_23:
    s_waitcnt lgkmcnt(4)
    v_mfma_f32_32x32x16_bf16 v[176:191], v[16:19], v[60:63], v[176:191]
    ds_read_b64_tr_b16 v[56:57], v1 offset:6272
    v_mfma_f32_32x32x16_bf16 v[192:207], v[20:23], v[60:63], v[192:207]
    ds_read_b64_tr_b16 v[58:59], v1 offset:7808
    s_waitcnt vmcnt(7)
    s_barrier
    s_cmp_lt_u32 s32, 8
    s_cselect_b32 s82, s29, 2147418112
    s_add_u32 s29, s29, s85
    s_cmp_lt_u32 s32, 7
    s_cselect_b32 s83, s27, 2147418112
    s_cselect_b32 s84, s28, 2147418112
    s_add_u32 s27, s27, 128
    s_add_u32 s28, s28, 128
    ds_read_b128 v[64:67], v13 offset:64
    s_waitcnt lgkmcnt(5)
    v_mfma_f32_32x32x16_bf16 v[80:95], v[48:51], v[24:27], v[80:95]
    ds_read_b64_tr_b16 v[60:61], v2 offset:6272
    s_add_u32 m0, s31, 0
    v_mfma_f32_32x32x16_bf16 v[96:111], v[48:51], v[28:31], v[96:111]
    ds_read_b64_tr_b16 v[62:63], v2 offset:7808
    s_mov_b64 exec, s[42:43]
    buffer_load_dwordx4 v10, s[8:11], s82 offen lds
    s_mov_b64 exec, -1
    s_cmp_eq_u32 s86, 0
    s_cbranch_scc1 nodot_24
    s_cmp_eq_u32 s86, 2
    s_cbranch_scc1 dot1_25
    v_dot2c_f32_bf16 v72, v24, v68
    v_dot2c_f32_bf16 v72, v25, v69
    v_dot2c_f32_bf16 v72, v26, v70
    v_dot2c_f32_bf16 v72, v27, v71
    s_branch nodot_24
dot1_25:
    v_dot2c_f32_bf16 v72, v28, v68
    v_dot2c_f32_bf16 v72, v29, v69
    v_dot2c_f32_bf16 v72, v30, v70
    v_dot2c_f32_bf16 v72, v31, v71
nodot_24:
    v_add_u32 v1, 12288, v1
    v_add_u32 v2, 12288, v2
    s_waitcnt lgkmcnt(5)
    v_mfma_f32_32x32x16_bf16 v[112:127], v[52:55], v[24:27], v[112:127]
    ds_read_b64_tr_b16 v[48:49], v1 offset:0
    s_add_u32 m0, s31, 1024
    v_mfma_f32_32x32x16_bf16 v[128:143], v[52:55], v[28:31], v[128:143]
    ds_read_b64_tr_b16 v[50:51], v1 offset:1536
    s_mov_b64 exec, s[44:45]
    buffer_load_dwordx4 v11, s[8:11], s82 offen lds
    s_mov_b64 exec, -1
    s_waitcnt lgkmcnt(5)
    v_mfma_f32_32x32x16_bf16 v[144:159], v[56:59], v[24:27], v[144:159]
    ds_read_b64_tr_b16 v[52:53], v2 offset:0
    s_add_u32 m0, s31, 2048
    v_mfma_f32_32x32x16_bf16 v[160:175], v[56:59], v[28:31], v[160:175]
    ds_read_b64_tr_b16 v[54:55], v2 offset:1536
    s_mov_b64 exec, s[46:47]
    buffer_load_dwordx4 v12, s[8:11], s82 offen lds
    s_mov_b64 exec, -1
    s_add_u32 s34, s34, 1
    s_and_b32 s34, s34, 3
    s_mul_i32 s31, s34, 12288
    s_add_u32 s31, s31, s35
    s_waitcnt lgkmcnt(4)
    v_mfma_f32_32x32x16_bf16 v[176:191], v[24:27], v[60:63], v[176:191]
    ds_read_b64_tr_b16 v[56:57], v1 offset:128
    s_add_u32 m0, s30, 0
    v_mfma_f32_32x32x16_bf16 v[192:207], v[28:31], v[60:63], v[192:207]
    ds_read_b64_tr_b16 v[58:59], v1 offset:1664
    buffer_load_dwordx4 v8, s[4:7], s83 offen lds
    ds_read_b128 v[68:71], v13 offset:96
    s_waitcnt lgkmcnt(5)
    v_mfma_f32_32x32x16_bf16 v[80:95], v[48:51], v[32:35], v[80:95]
    ds_read_b64_tr_b16 v[60:61], v2 offset:128
    s_add_u32 m0, s30, 1024
    v_mfma_f32_32x32x16_bf16 v[96:111], v[48:51], v[36:39], v[96:111]
    ds_read_b64_tr_b16 v[62:63], v2 offset:1664
    buffer_load_dwordx4 v9, s[4:7], s83 offen lds
    s_cmp_eq_u32 s86, 0
    s_cbranch_scc1 nodot_26
    s_cmp_eq_u32 s86, 2
    s_cbranch_scc1 dot1_27
    v_dot2c_f32_bf16 v72, v32, v64
    v_dot2c_f32_bf16 v72, v33, v65
    v_dot2c_f32_bf16 v72, v34, v66
    v_dot2c_f32_bf16 v72, v35, v67
    s_branch nodot_26
dot1_27:
    v_dot2c_f32_bf16 v72, v36, v64
    v_dot2c_f32_bf16 v72, v37, v65
    v_dot2c_f32_bf16 v72, v38, v66
    v_dot2c_f32_bf16 v72, v39, v67
nodot_26:
    s_waitcnt lgkmcnt(5)
    v_mfma_f32_32x32x16_bf16 v[112:127], v[52:55], v[32:35], v[112:127]
    ds_read_b64_tr_b16 v[48:49], v1 offset:6144
    s_add_u32 m0, s30, 2048
    v_mfma_f32_32x32x16_bf16 v[128:143], v[52:55], v[36:39], v[128:143]
    ds_read_b64_tr_b16 v[50:51], v1 offset:7680
    buffer_load_dwordx4 v8, s[4:7], s84 offen lds
    s_waitcnt lgkmcnt(5)
    v_mfma_f32_32x32x16_bf16 v[144:159], v[56:59], v[32:35], v[144:159]
    ds_read_b64_tr_b16 v[52:53], v2 offset:6144
    s_add_u32 m0, s30, 3072
    v_mfma_f32_32x32x16_bf16 v[160:175], v[56:59], v[36:39], v[160:175]
    ds_read_b64_tr_b16 v[54:55], v2 offset:7680
    buffer_load_dwordx4 v9, s[4:7], s84 offen lds
    s_xor_b32 s30, s30, 32768
    s_waitcnt lgkmcnt(4)
    v_mfma_f32_32x32x16_bf16 v[176:191], v[32:35], v[60:63], v[176:191]
    ds_read_b64_tr_b16 v[56:57], v1 offset:6272
    v_mfma_f32_32x32x16_bf16 v[192:207], v[36:39], v[60:63], v[192:207]
    ds_read_b64_tr_b16 v[58:59], v1 offset:7808
    s_waitcnt vmcnt(7)
    s_barrier
    s_cmp_lt_u32 s32, 7
    s_cselect_b32 s82, s29, 2147418112
    s_add_u32 s29, s29, s85
    ds_read_b128 v[16:19], v4 offset:0
    ds_read_b128 v[20:23], v4 offset:4096
    ds_read_b128 v[24:27], v5 offset:0
    ds_read_b128 v[28:31], v5 offset:4096
    ds_read_b128 v[32:35], v6 offset:0
    ds_read_b128 v[36:39], v6 offset:4096
    v_add_u32 v13, 384, v13
    ds_read_b128 v[64:67], v13 offset:0
    s_waitcnt lgkmcnt(11)
    v_mfma_f32_32x32x16_bf16 v[80:95], v[48:51], v[40:43], v[80:95]
    ds_read_b64_tr_b16 v[60:61], v2 offset:6272
    s_add_u32 m0, s31, 0
    v_mfma_f32_32x32x16_bf16 v[96:111], v[48:51], v[44:47], v[96:111]
    ds_read_b64_tr_b16 v[62:63], v2 offset:7808
    s_mov_b64 exec, s[42:43]
    buffer_load_dwordx4 v10, s[8:11], s82 offen lds
    s_mov_b64 exec, -1
    s_cmp_eq_u32 s86, 0
    s_cbranch_scc1 nodot_28
    s_cmp_eq_u32 s86, 2
    s_cbranch_scc1 dot1_29
    v_dot2c_f32_bf16 v72, v40, v68
    v_dot2c_f32_bf16 v72, v41, v69
    v_dot2c_f32_bf16 v72, v42, v70
    v_dot2c_f32_bf16 v72, v43, v71
    s_branch nodot_28
dot1_29:
    v_dot2c_f32_bf16 v72, v44, v68
    v_dot2c_f32_bf16 v72, v45, v69
    v_dot2c_f32_bf16 v72, v46, v70
    v_dot2c_f32_bf16 v72, v47, v71
nodot_28:
    v_add_u32 v1, s33, v1
    v_add_u32 v2, s33, v2
    s_sub_u32 s33, 4294942720, s33
    s_waitcnt lgkmcnt(11)
    v_mfma_f32_32x32x16_bf16 v[112:127], v[52:55], v[40:43], v[112:127]
    ds_read_b64_tr_b16 v[48:49], v1 offset:0
    s_add_u32 m0, s31, 1024
    v_mfma_f32_32x32x16_bf16 v[128:143], v[52:55], v[44:47], v[128:143]
    ds_read_b64_tr_b16 v[50:51], v1 offset:1536
    s_mov_b64 exec, s[44:45]
    buffer_load_dwordx4 v11, s[8:11], s82 offen lds
    s_mov_b64 exec, -1
    s_waitcnt lgkmcnt(11)
    v_mfma_f32_32x32x16_bf16 v[144:159], v[56:59], v[40:43], v[144:159]
    ds_read_b64_tr_b16 v[52:53], v2 offset:0
    s_add_u32 m0, s31, 2048
    v_mfma_f32_32x32x16_bf16 v[160:175], v[56:59], v[44:47], v[160:175]
    ds_read_b64_tr_b16 v[54:55], v2 offset:1536
    s_mov_b64 exec, s[46:47]
    buffer_load_dwordx4 v12, s[8:11], s82 offen lds
    s_mov_b64 exec, -1
    s_add_u32 s34, s34, 1
    s_and_b32 s34, s34, 3
    s_mul_i32 s31, s34, 12288
    s_add_u32 s31, s31, s35
    s_waitcnt lgkmcnt(4)
    v_mfma_f32_32x32x16_bf16 v[176:191], v[40:43], v[60:63], v[176:191]
    ds_read_b64_tr_b16 v[56:57], v1 offset:128
    v_mfma_f32_32x32x16_bf16 v[192:207], v[44:47], v[60:63], v[192:207]
    ds_read_b64_tr_b16 v[58:59], v1 offset:1664
    s_add_u32 s32, s32, 1
    s_cmp_lt_u32 s32, 9
    s_cbranch_scc1 loop_18
    s_waitcnt lgkmcnt(0)
    s_branch cgj_17
cg1_16:
    ds_read_b128 v[16:19], v4 offset:0
    ds_read_b128 v[20:23], v4 offset:4096
    ds_read_b128 v[24:27], v5 offset:0
    ds_read_b128 v[28:31], v5 offset:4096
    ds_read_b128 v[32:35], v6 offset:0
    ds_read_b128 v[36:39], v6 offset:4096
    s_waitcnt lgkmcnt(0)
    ds_read_b64_tr_b16 v[48:49], v1 offset:256
    ds_read_b64_tr_b16 v[50:51], v1 offset:1792
    ds_read_b64_tr_b16 v[52:53], v2 offset:256
    ds_read_b64_tr_b16 v[54:55], v2 offset:1792
    ds_read_b64_tr_b16 v[56:57], v1 offset:49152
    ds_read_b64_tr_b16 v[58:59], v1 offset:50688
    s_mov_b32 s32, 0
loop_30:
    ds_read_b128 v[40:43], v7 offset:0
    ds_read_b128 v[44:47], v7 offset:4096
    v_xor_b32 v4, 32768, v4
    v_xor_b32 v5, 32768, v5
    v_xor_b32 v6, 32768, v6
    v_xor_b32 v7, 32768, v7
    s_waitcnt lgkmcnt(6)
    v_mfma_f32_32x32x16_bf16 v[80:95], v[16:19], v[48:51], v[80:95]
    ds_read_b64_tr_b16 v[60:61], v2 offset:49152
    v_mfma_f32_32x32x16_bf16 v[96:111], v[20:23], v[48:51], v[96:111]
    ds_read_b64_tr_b16 v[62:63], v2 offset:50688
    s_cmp_lg_u32 s32, 0
    s_cbranch_scc1 nrmp_31
    s_mov_b32 s83, s27
    s_mov_b32 s84, s28
    s_add_u32 s27, s27, 128
    s_add_u32 s28, s28, 128
    s_add_u32 m0, s30, 0
    s_nop 0
    buffer_load_dwordx4 v8, s[4:7], s83 offen lds
    s_add_u32 m0, s30, 1024
    s_nop 0
    buffer_load_dwordx4 v9, s[4:7], s83 offen lds
nrmp_31:
    s_waitcnt lgkmcnt(6)
    v_mfma_f32_32x32x16_bf16 v[112:127], v[16:19], v[52:55], v[112:127]
    ds_read_b64_tr_b16 v[48:49], v1 offset:49280
    v_mfma_f32_32x32x16_bf16 v[128:143], v[20:23], v[52:55], v[128:143]
    ds_read_b64_tr_b16 v[50:51], v1 offset:50816
    s_cmp_lg_u32 s32, 0
    s_cbranch_scc1 nrmp_32
    s_add_u32 m0, s30, 2048
    s_nop 0
    buffer_load_dwordx4 v8, s[4:7], s84 offen lds
    s_add_u32 m0, s30, 3072
    s_nop 0
    buffer_load_dwordx4 v9, s[4:7], s84 offen lds
    s_xor_b32 s30, s30, 32768
nrmp_32:
    s_waitcnt lgkmcnt(6)
    v_mfma_f32_32x32x16_bf16 v[144:159], v[16:19], v[56:59], v[144:159]
    ds_read_b64_tr_b16 v[52:53], v1 offset:6400
    v_mfma_f32_32x32x16_bf16 v[160:175], v[20:23], v[56:59], v[160:175]
    ds_read_b64_tr_b16 v[54:55], v1 offset:7936
    s_cmp_lg_u32 s32, 0
    s_cbranch_scc1 nrmp_33
    s_mov_b32 s82, s29
    s_add_u32 s29, s29, s85
    s_add_u32 m0, s31, 0
    s_nop 0
    s_mov_b64 exec, s[42:43]
    buffer_load_dwordx4 v10, s[8:11], s82 offen lds
    s_mov_b64 exec, -1
    s_add_u32 m0, s31, 1024
    s_nop 0
    s_mov_b64 exec, s[44:45]
    buffer_load_dwordx4 v11, s[8:11], s82 offen lds
    s_mov_b64 exec, -1
nrmp_33:
    s_waitcnt lgkmcnt(4)
    v_mfma_f32_32x32x16_bf16 v[176:191], v[16:19], v[60:63], v[176:191]
    ds_read_b64_tr_b16 v[56:57], v2 offset:6400
    v_mfma_f32_32x32x16_bf16 v[192:207], v[20:23], v[60:63], v[192:207]
    ds_read_b64_tr_b16 v[58:59], v2 offset:7936
    s_cmp_lg_u32 s32, 0
    s_cbranch_scc1 nrmp_34
    s_add_u32 m0, s31, 2048
    s_nop 0
    s_mov_b64 exec, s[46:47]
    buffer_load_dwordx4 v12, s[8:11], s82 offen lds
    s_mov_b64 exec, -1
    s_add_u32 s34, s34, 1
    s_and_b32 s34, s34, 3
    s_mul_i32 s31, s34, 12288
    s_add_u32 s31, s31, s35
nrmp_34:
    s_waitcnt lgkmcnt(4)
    v_mfma_f32_32x32x16_bf16 v[208:223], v[16:19], v[48:51], v[208:223]
    ds_read_b64_tr_b16 v[60:61], v1 offset:55296
    v_mfma_f32_32x32x16_bf16 v[224:239], v[20:23], v[48:51], v[224:239]
    ds_read_b64_tr_b16 v[62:63], v1 offset:56832
    s_waitcnt vmcnt(7)
    s_barrier
    s_cmp_lt_u32 s32, 8
    s_cselect_b32 s82, s29, 2147418112
    s_add_u32 s29, s29, s85
    s_cmp_lt_u32 s32, 7
    s_cselect_b32 s83, s27, 2147418112
    s_cselect_b32 s84, s28, 2147418112
    s_add_u32 s27, s27, 128
    s_add_u32 s28, s28, 128
    s_waitcnt lgkmcnt(4)
    v_mfma_f32_32x32x16_bf16 v[80:95], v[24:27], v[52:55], v[80:95]
    ds_read_b64_tr_b16 v[48:49], v2 offset:55296
    s_add_u32 m0, s31, 0
    v_mfma_f32_32x32x16_bf16 v[96:111], v[28:31], v[52:55], v[96:111]
    ds_read_b64_tr_b16 v[50:51], v2 offset:56832
    s_mov_b64 exec, s[42:43]
    buffer_load_dwordx4 v10, s[8:11], s82 offen lds
    s_mov_b64 exec, -1
    s_waitcnt lgkmcnt(4)
    v_mfma_f32_32x32x16_bf16 v[112:127], v[24:27], v[56:59], v[112:127]
    ds_read_b64_tr_b16 v[52:53], v1 offset:55424
    s_add_u32 m0, s31, 1024
    v_mfma_f32_32x32x16_bf16 v[128:143], v[28:31], v[56:59], v[128:143]
    ds_read_b64_tr_b16 v[54:55], v1 offset:56960
    s_mov_b64 exec, s[44:45]
    buffer_load_dwordx4 v11, s[8:11], s82 offen lds
    s_mov_b64 exec, -1
    v_add_u32 v1, 12288, v1
    v_add_u32 v2, 12288, v2
    s_waitcnt lgkmcnt(4)
    v_mfma_f32_32x32x16_bf16 v[144:159], v[24:27], v[60:63], v[144:159]
    ds_read_b64_tr_b16 v[56:57], v1 offset:256
    s_add_u32 m0, s31, 2048
    v_mfma_f32_32x32x16_bf16 v[160:175], v[28:31], v[60:63], v[160:175]
    ds_read_b64_tr_b16 v[58:59], v1 offset:1792
    s_mov_b64 exec, s[46:47]
    buffer_load_dwordx4 v12, s[8:11], s82 offen lds
    s_mov_b64 exec, -1
    s_add_u32 s34, s34, 1
    s_and_b32 s34, s34, 3
    s_mul_i32 s31, s34, 12288
    s_add_u32 s31, s31, s35
    s_waitcnt lgkmcnt(4)
    v_mfma_f32_32x32x16_bf16 v[176:191], v[24:27], v[48:51], v[176:191]
    ds_read_b64_tr_b16 v[60:61], v2 offset:256
    s_add_u32 m0, s30, 0
    v_mfma_f32_32x32x16_bf16 v[192:207], v[28:31], v[48:51], v[192:207]
    ds_read_b64_tr_b16 v[62:63], v2 offset:1792
    buffer_load_dwordx4 v8, s[4:7], s83 offen lds
    s_waitcnt lgkmcnt(4)
    v_mfma_f32_32x32x16_bf16 v[208:223], v[24:27], v[52:55], v[208:223]
    ds_read_b64_tr_b16 v[48:49], v1 offset:49152
    s_add_u32 m0, s30, 1024
    v_mfma_f32_32x32x16_bf16 v[224:239], v[28:31], v[52:55], v[224:239]
    ds_read_b64_tr_b16 v[50:51], v1 offset:50688
    buffer_load_dwordx4 v9, s[4:7], s83 offen lds
    s_waitcnt lgkmcnt(4)
    v_mfma_f32_32x32x16_bf16 v[80:95], v[32:35], v[56:59], v[80:95]
    ds_read_b64_tr_b16 v[52:53], v2 offset:49152
    s_add_u32 m0, s30, 2048
    v_mfma_f32_32x32x16_bf16 v[96:111], v[36:39], v[56:59], v[96:111]
    ds_read_b64_tr_b16 v[54:55], v2 offset:50688
    buffer_load_dwordx4 v8, s[4:7], s84 offen lds
    s_waitcnt lgkmcnt(4)
    v_mfma_f32_32x32x16_bf16 v[112:127], v[32:35], v[60:63], v[112:127]
    ds_read_b64_tr_b16 v[56:57], v1 offset:49280
    s_add_u32 m0, s30, 3072
    v_mfma_f32_32x32x16_bf16 v[128:143], v[36:39], v[60:63], v[128:143]
    ds_read_b64_tr_b16 v[58:59], v1 offset:50816
    buffer_load_dwordx4 v9, s[4:7], s84 offen lds
    s_xor_b32 s30, s30, 32768
    s_waitcnt lgkmcnt(4)
    v_mfma_f32_32x32x16_bf16 v[144:159], v[32:35], v[48:51], v[144:159]
    ds_read_b64_tr_b16 v[60:61], v1 offset:6400
    v_mfma_f32_32x32x16_bf16 v[160:175], v[36:39], v[48:51], v[160:175]
    ds_read_b64_tr_b16 v[62:63], v1 offset:7936
    s_waitcnt lgkmcnt(4)
    v_mfma_f32_32x32x16_bf16 v[176:191], v[32:35], v[52:55], v[176:191]
    ds_read_b64_tr_b16 v[48:49], v2 offset:6400
    v_mfma_f32_32x32x16_bf16 v[192:207], v[36:39], v[52:55], v[192:207]
    ds_read_b64_tr_b16 v[50:51], v2 offset:7936
    s_waitcnt lgkmcnt(4)
    v_mfma_f32_32x32x16_bf16 v[208:223], v[32:35], v[56:59], v[208:223]
    ds_read_b64_tr_b16 v[52:53], v1 offset:55296
    v_mfma_f32_32x32x16_bf16 v[224:239], v[36:39], v[56:59], v[224:239]
    ds_read_b64_tr_b16 v[54:55], v1 offset:56832
    s_waitcnt vmcnt(7)
    s_barrier
    s_cmp_lt_u32 s32, 7
    s_cselect_b32 s82, s29, 2147418112
    s_add_u32 s29, s29, s85
    ds_read_b128 v[16:19], v4 offset:0
    ds_read_b128 v[20:23], v4 offset:4096
    ds_read_b128 v[24:27], v5 offset:0
    ds_read_b128 v[28:31], v5 offset:4096
    ds_read_b128 v[32:35], v6 offset:0
    ds_read_b128 v[36:39], v6 offset:4096
    s_waitcnt lgkmcnt(10)
    v_mfma_f32_32x32x16_bf16 v[80:95], v[40:43], v[60:63], v[80:95]
    ds_read_b64_tr_b16 v[56:57], v2 offset:55296
    s_add_u32 m0, s31, 0
    v_mfma_f32_32x32x16_bf16 v[96:111], v[44:47], v[60:63], v[96:111]
    ds_read_b64_tr_b16 v[58:59], v2 offset:56832
    s_mov_b64 exec, s[42:43]
    buffer_load_dwordx4 v10, s[8:11], s82 offen lds
    s_mov_b64 exec, -1
    s_waitcnt lgkmcnt(10)
    v_mfma_f32_32x32x16_bf16 v[112:127], v[40:43], v[48:51], v[112:127]
    ds_read_b64_tr_b16 v[60:61], v1 offset:55424
    s_add_u32 m0, s31, 1024
    v_mfma_f32_32x32x16_bf16 v[128:143], v[44:47], v[48:51], v[128:143]
    ds_read_b64_tr_b16 v[62:63], v1 offset:56960
    s_mov_b64 exec, s[44:45]
    buffer_load_dwordx4 v11, s[8:11], s82 offen lds
    s_mov_b64 exec, -1
    v_add_u32 v1, s33, v1
    v_add_u32 v2, s33, v2
    s_sub_u32 s33, 4294942720, s33
    s_waitcnt lgkmcnt(10)
    v_mfma_f32_32x32x16_bf16 v[144:159], v[40:43], v[52:55], v[144:159]
    ds_read_b64_tr_b16 v[48:49], v1 offset:256
    s_add_u32 m0, s31, 2048
    v_mfma_f32_32x32x16_bf16 v[160:175], v[44:47], v[52:55], v[160:175]
    ds_read_b64_tr_b16 v[50:51], v1 offset:1792
    s_mov_b64 exec, s[46:47]
    buffer_load_dwordx4 v12, s[8:11], s82 offen lds
    s_mov_b64 exec, -1
    s_add_u32 s34, s34, 1
    s_and_b32 s34, s34, 3
    s_mul_i32 s31, s34, 12288
    s_add_u32 s31, s31, s35
    s_waitcnt lgkmcnt(4)
    v_mfma_f32_32x32x16_bf16 v[176:191], v[40:43], v[56:59], v[176:191]
    ds_read_b64_tr_b16 v[52:53], v2 offset:256
    v_mfma_f32_32x32x16_bf16 v[192:207], v[44:47], v[56:59], v[192:207]
    ds_read_b64_tr_b16 v[54:55], v2 offset:1792
    s_waitcnt lgkmcnt(4)
    v_mfma_f32_32x32x16_bf16 v[208:223], v[40:43], v[60:63], v[208:223]
    ds_read_b64_tr_b16 v[56:57], v1 offset:49152
    v_mfma_f32_32x32x16_bf16 v[224:239], v[44:47], v[60:63], v[224:239]
    ds_read_b64_tr_b16 v[58:59], v1 offset:50688
    s_add_u32 s32, s32, 1
    s_cmp_lt_u32 s32, 9
    s_cbranch_scc1 loop_30
    s_waitcnt lgkmcnt(0)
cgj_17:
    s_cmp_lg_u32 s24, 0
    s_cbranch_scc1 nrdy_35
    s_mov_b32 s20, s66
    s_and_b32 s21, s67, 0xffff
    s_mov_b32 s22, 256
    s_mov_b32 s23, 0x00020000
    v_mov_b32 v17, 0
    s_mov_b32 s88, 0
rdy_36:
    buffer_load_dword v16, v17, s[20:23], 0 offen sc1
    s_waitcnt vmcnt(0)
    v_readfirstlane_b32 s89, v16
    s_add_u32 s88, s88, 1
    s_cmp_ge_u32 s88, 0x40000
    s_cbranch_scc1 nrdy_35
    s_cmp_eq_u32 s89, 0
    s_cbranch_scc1 rdy_36
nrdy_35:
    s_mul_i32 s36, s25, 4608
    s_lshl_b32 s37, s24, 10
    s_add_u32 s36, s36, s37
    s_add_u32 s36, s36, 45088768
    s_lshl_b32 s37, s25, 8
    s_add_u32 s37, s37, 45125632
    s_cmp_eq_u32 s24, 5
    s_cselect_b32 s36, s37, s36
    s_cselect_b32 s38, 16, 64
    s_cmp_eq_u32 s24, 4
    s_cselect_b32 s38, 32, s38
    s_cmp_gt_u32 s24, 5
    s_cselect_b32 s38, 0, s38
    s_cmp_lg_u32 s26, 0
    s_cselect_b32 s38, 0, s38
    v_mov_b32 v16, 0
    v_mov_b32 v17, 0
    v_mov_b32 v18, 0
    v_mov_b32 v19, 0
    v_lshlrev_b32 v1, 4, v14
    v_mov_b32 v2, 0x40000000
    v_cmp_gt_u32 vcc, s38, v14
    s_nop 1
    v_cndmask_b32 v2, v2, v1, vcc
    buffer_store_dwordx4 v[16:19], v2, s[12:15], s36 offen sc1
    s_waitcnt vmcnt(0)
    s_barrier
    s_and_b32 s37, s24, 3
    s_lshl_b32 s37, s37, 12
    v_lshlrev_b32 v1, 4, v14
    v_add_u32 v2, s37, v1
    v_add_u32 v4, 49152, v2
    s_cmp_ge_u32 s24, 4
    s_cbranch_scc1 vpath_37
    v_min_f32 v32, 0, v176
    v_min_f32 v33, 0, v177
    v_min_f32 v34, 0, v178
    v_min_f32 v35, 0, v179
    v_min_f32 v36, 0, v180
    v_min_f32 v37, 0, v181
    v_min_f32 v38, 0, v182
    v_min_f32 v39, 0, v183
    v_pk_mul_f32 v[32:33], v[32:33], s[70:71]
    v_pk_mul_f32 v[34:35], v[34:35], s[70:71]
    v_pk_mul_f32 v[36:37], v[36:37], s[70:71]
    v_pk_mul_f32 v[38:39], v[38:39], s[70:71]
    v_exp_f32 v32, v32
    v_exp_f32 v33, v33
    v_exp_f32 v34, v34
    v_exp_f32 v35, v35
    v_exp_f32 v36, v36
    v_exp_f32 v37, v37
    v_exp_f32 v38, v38
    v_exp_f32 v39, v39
    v_max_f32 v40, 0, v176
    v_max_f32 v41, 0, v177
    v_max_f32 v42, 0, v178
    v_max_f32 v43, 0, v179
    v_max_f32 v44, 0, v180
    v_max_f32 v45, 0, v181
    v_max_f32 v46, 0, v182
    v_max_f32 v47, 0, v183
    v_pk_add_f32 v[32:33], v[32:33], v[40:41]
    v_pk_add_f32 v[34:35], v[34:35], v[42:43]
    v_pk_add_f32 v[36:37], v[36:37], v[44:45]
    v_pk_add_f32 v[38:39], v[38:39], v[46:47]
    v_pk_add_f32 v[32:33], v[32:33], s[72:73]
    v_pk_add_f32 v[34:35], v[34:35], s[72:73]
    v_pk_add_f32 v[36:37], v[36:37], s[72:73]
    v_pk_add_f32 v[38:39], v[38:39], s[72:73]
    v_cvt_pk_bf16_f32 v16, v32, v33
    v_cvt_pk_bf16_f32 v17, v34, v35
    v_cvt_pk_bf16_f32 v18, v36, v37
    v_cvt_pk_bf16_f32 v19, v38, v39
    ds_write_b128 v2, v[16:19] offset:0
    v_min_f32 v32, 0, v184
    v_min_f32 v33, 0, v185
    v_min_f32 v34, 0, v186
    v_min_f32 v35, 0, v187
    v_min_f32 v36, 0, v188
    v_min_f32 v37, 0, v189
    v_min_f32 v38, 0, v190
    v_min_f32 v39, 0, v191
    v_pk_mul_f32 v[32:33], v[32:33], s[70:71]
    v_pk_mul_f32 v[34:35], v[34:35], s[70:71]
    v_pk_mul_f32 v[36:37], v[36:37], s[70:71]
    v_pk_mul_f32 v[38:39], v[38:39], s[70:71]
    v_exp_f32 v32, v32
    v_exp_f32 v33, v33
    v_exp_f32 v34, v34
    v_exp_f32 v35, v35
    v_exp_f32 v36, v36
    v_exp_f32 v37, v37
    v_exp_f32 v38, v38
    v_exp_f32 v39, v39
    v_max_f32 v40, 0, v184
    v_max_f32 v41, 0, v185
    v_max_f32 v42, 0, v186
    v_max_f32 v43, 0, v187
    v_max_f32 v44, 0, v188
    v_max_f32 v45, 0, v189
    v_max_f32 v46, 0, v190
    v_max_f32 v47, 0, v191
    v_pk_add_f32 v[32:33], v[32:33], v[40:41]
    v_pk_add_f32 v[34:35], v[34:35], v[42:43]
    v_pk_add_f32 v[36:37], v[36:37], v[44:45]
    v_pk_add_f32 v[38:39], v[38:39], v[46:47]
    v_pk_add_f32 v[32:33], v[32:33], s[72:73]
    v_pk_add_f32 v[34:35], v[34:35], s[72:73]
    v_pk_add_f32 v[36:37], v[36:37], s[72:73]
    v_pk_add_f32 v[38:39], v[38:39], s[72:73]
    v_cvt_pk_bf16_f32 v20, v32, v33
    v_cvt_pk_bf16_f32 v21, v34, v35
    v_cvt_pk_bf16_f32 v22, v36, v37
    v_cvt_pk_bf16_f32 v23, v38, v39
    ds_write_b128 v2, v[20:23] offset:1024
    v_min_f32 v32, 0, v192
    v_min_f32 v33, 0, v193
    v_min_f32 v34, 0, v194
    v_min_f32 v35, 0, v195
    v_min_f32 v36, 0, v196
    v_min_f32 v37, 0, v197
    v_min_f32 v38, 0, v198
    v_min_f32 v39, 0, v199
    v_pk_mul_f32 v[32:33], v[32:33], s[70:71]
    v_pk_mul_f32 v[34:35], v[34:35], s[70:71]
    v_pk_mul_f32 v[36:37], v[36:37], s[70:71]
    v_pk_mul_f32 v[38:39], v[38:39], s[70:71]
    v_exp_f32 v32, v32
    v_exp_f32 v33, v33
    v_exp_f32 v34, v34
    v_exp_f32 v35, v35
    v_exp_f32 v36, v36
    v_exp_f32 v37, v37
    v_exp_f32 v38, v38
    v_exp_f32 v39, v39
    v_max_f32 v40, 0, v192
    v_max_f32 v41, 0, v193
    v_max_f32 v42, 0, v194
    v_max_f32 v43, 0, v195
    v_max_f32 v44, 0, v196
    v_max_f32 v45, 0, v197
    v_max_f32 v46, 0, v198
    v_max_f32 v47, 0, v199
    v_pk_add_f32 v[32:33], v[32:33], v[40:41]
    v_pk_add_f32 v[34:35], v[34:35], v[42:43]
    v_pk_add_f32 v[36:37], v[36:37], v[44:45]
    v_pk_add_f32 v[38:39], v[38:39], v[46:47]
    v_pk_add_f32 v[32:33], v[32:33], s[72:73]
    v_pk_add_f32 v[34:35], v[34:35], s[72:73]
    v_pk_add_f32 v[36:37], v[36:37], s[72:73]
    v_pk_add_f32 v[38:39], v[38:39], s[72:73]
    v_cvt_pk_bf16_f32 v16, v32, v33
    v_cvt_pk_bf16_f32 v17, v34, v35
    v_cvt_pk_bf16_f32 v18, v36, v37
    v_cvt_pk_bf16_f32 v19, v38, v39
    ds_write_b128 v2, v[16:19] offset:2048
    v_min_f32 v32, 0, v200
    v_min_f32 v33, 0, v201
    v_min_f32 v34, 0, v202
    v_min_f32 v35, 0, v203
    v_min_f32 v36, 0, v204
    v_min_f32 v37, 0, v205
    v_min_f32 v38, 0, v206
    v_min_f32 v39, 0, v207
    v_pk_mul_f32 v[32:33], v[32:33], s[70:71]
    v_pk_mul_f32 v[34:35], v[34:35], s[70:71]
    v_pk_mul_f32 v[36:37], v[36:37], s[70:71]
    v_pk_mul_f32 v[38:39], v[38:39], s[70:71]
    v_exp_f32 v32, v32
    v_exp_f32 v33, v33
    v_exp_f32 v34, v34
    v_exp_f32 v35, v35
    v_exp_f32 v36, v36
    v_exp_f32 v37, v37
    v_exp_f32 v38, v38
    v_exp_f32 v39, v39
    v_max_f32 v40, 0, v200
    v_max_f32 v41, 0, v201
    v_max_f32 v42, 0, v202
    v_max_f32 v43, 0, v203
    v_max_f32 v44, 0, v204
    v_max_f32 v45, 0, v205
    v_max_f32 v46, 0, v206
    v_max_f32 v47, 0, v207
    v_pk_add_f32 v[32:33], v[32:33], v[40:41]
    v_pk_add_f32 v[34:35], v[34:35], v[42:43]
    v_pk_add_f32 v[36:37], v[36:37], v[44:45]
    v_pk_add_f32 v[38:39], v[38:39], v[46:47]
    v_pk_add_f32 v[32:33], v[32:33], s[72:73]
    v_pk_add_f32 v[34:35], v[34:35], s[72:73]
    v_pk_add_f32 v[36:37], v[36:37], s[72:73]
    v_pk_add_f32 v[38:39], v[38:39], s[72:73]
    v_cvt_pk_bf16_f32 v20, v32, v33
    v_cvt_pk_bf16_f32 v21, v34, v35
    v_cvt_pk_bf16_f32 v22, v36, v37
    v_cvt_pk_bf16_f32 v23, v38, v39
    ds_write_b128 v2, v[20:23] offset:3072
    s_waitcnt lgkmcnt(0)
    s_branch kvjoin_38
vpath_37:
    v_and_b32 v15, 31, v14
    v_cmp_eq_u32 vcc, 8, v15
    v_mov_b32 v15, 0x3f803f80
    v_cvt_pk_bf16_f32 v16, v144, v145
    v_cvt_pk_bf16_f32 v17, v146, v147
    v_cvt_pk_bf16_f32 v18, v148, v149
    v_cvt_pk_bf16_f32 v19, v150, v151
    ds_write_b128 v4, v[16:19] offset:0
    v_cvt_pk_bf16_f32 v20, v152, v153
    v_cvt_pk_bf16_f32 v21, v154, v155
    v_cvt_pk_bf16_f32 v22, v156, v157
    v_cvt_pk_bf16_f32 v23, v158, v159
    ds_write_b128 v4, v[20:23] offset:1024
    v_cvt_pk_bf16_f32 v16, v160, v161
    v_cvt_pk_bf16_f32 v17, v162, v163
    v_cvt_pk_bf16_f32 v18, v164, v165
    v_cvt_pk_bf16_f32 v19, v166, v167
    ds_write_b128 v4, v[16:19] offset:2048
    v_cvt_pk_bf16_f32 v20, v168, v169
    v_cvt_pk_bf16_f32 v21, v170, v171
    v_cvt_pk_bf16_f32 v22, v172, v173
    v_cvt_pk_bf16_f32 v23, v174, v175
    ds_write_b128 v4, v[20:23] offset:3072
    v_cvt_pk_bf16_f32 v16, v176, v177
    v_cvt_pk_bf16_f32 v17, v178, v179
    v_cvt_pk_bf16_f32 v18, v180, v181
    v_cvt_pk_bf16_f32 v19, v182, v183
    ds_write_b128 v4, v[16:19] offset:16384
    v_cvt_pk_bf16_f32 v20, v184, v185
    v_cvt_pk_bf16_f32 v21, v186, v187
    v_cvt_pk_bf16_f32 v22, v188, v189
    v_cvt_pk_bf16_f32 v23, v190, v191
    ds_write_b128 v4, v[20:23] offset:17408
    v_cvt_pk_bf16_f32 v16, v192, v193
    v_cvt_pk_bf16_f32 v17, v194, v195
    v_cvt_pk_bf16_f32 v18, v196, v197
    v_cvt_pk_bf16_f32 v19, v198, v199
    ds_write_b128 v4, v[16:19] offset:18432
    v_cvt_pk_bf16_f32 v20, v200, v201
    v_cvt_pk_bf16_f32 v21, v202, v203
    v_cvt_pk_bf16_f32 v22, v204, v205
    v_cvt_pk_bf16_f32 v23, v206, v207
    ds_write_b128 v4, v[20:23] offset:19456
    v_cvt_pk_bf16_f32 v16, v208, v209
    v_cvt_pk_bf16_f32 v17, v210, v211
    v_cvt_pk_bf16_f32 v18, v212, v213
    v_cvt_pk_bf16_f32 v19, v214, v215
    v_cndmask_b32 v16, v16, v15, vcc
    v_cndmask_b32 v17, v17, v15, vcc
    v_cndmask_b32 v18, v18, v15, vcc
    v_cndmask_b32 v19, v19, v15, vcc
    ds_write_b128 v4, v[16:19] offset:32768
    v_cvt_pk_bf16_f32 v20, v216, v217
    v_cvt_pk_bf16_f32 v21, v218, v219
    v_cvt_pk_bf16_f32 v22, v220, v221
    v_cvt_pk_bf16_f32 v23, v222, v223
    v_cndmask_b32 v20, v20, v15, vcc
    v_cndmask_b32 v21, v21, v15, vcc
    v_cndmask_b32 v22, v22, v15, vcc
    v_cndmask_b32 v23, v23, v15, vcc
    ds_write_b128 v4, v[20:23] offset:33792
    v_cvt_pk_bf16_f32 v16, v224, v225
    v_cvt_pk_bf16_f32 v17, v226, v227
    v_cvt_pk_bf16_f32 v18, v228, v229
    v_cvt_pk_bf16_f32 v19, v230, v231
    v_cndmask_b32 v16, v16, v15, vcc
    v_cndmask_b32 v17, v17, v15, vcc
    v_cndmask_b32 v18, v18, v15, vcc
    v_cndmask_b32 v19, v19, v15, vcc
    ds_write_b128 v4, v[16:19] offset:34816
    v_cvt_pk_bf16_f32 v20, v232, v233
    v_cvt_pk_bf16_f32 v21, v234, v235
    v_cvt_pk_bf16_f32 v22, v236, v237
    v_cvt_pk_bf16_f32 v23, v238, v239
    v_cndmask_b32 v20, v20, v15, vcc
    v_cndmask_b32 v21, v21, v15, vcc
    v_cndmask_b32 v22, v22, v15, vcc
    v_cndmask_b32 v23, v23, v15, vcc
    ds_write_b128 v4, v[20:23] offset:35840
    v_min_f32 v32, 0, v80
    v_min_f32 v33, 0, v81
    v_min_f32 v34, 0, v82
    v_min_f32 v35, 0, v83
    v_min_f32 v36, 0, v84
    v_min_f32 v37, 0, v85
    v_min_f32 v38, 0, v86
    v_min_f32 v39, 0, v87
    v_pk_mul_f32 v[32:33], v[32:33], s[70:71]
    v_pk_mul_f32 v[34:35], v[34:35], s[70:71]
    v_pk_mul_f32 v[36:37], v[36:37], s[70:71]
    v_pk_mul_f32 v[38:39], v[38:39], s[70:71]
    v_exp_f32 v32, v32
    v_exp_f32 v33, v33
    v_exp_f32 v34, v34
    v_exp_f32 v35, v35
    v_exp_f32 v36, v36
    v_exp_f32 v37, v37
    v_exp_f32 v38, v38
    v_exp_f32 v39, v39
    v_max_f32 v40, 0, v80
    v_max_f32 v41, 0, v81
    v_max_f32 v42, 0, v82
    v_max_f32 v43, 0, v83
    v_max_f32 v44, 0, v84
    v_max_f32 v45, 0, v85
    v_max_f32 v46, 0, v86
    v_max_f32 v47, 0, v87
    v_pk_add_f32 v[32:33], v[32:33], v[40:41]
    v_pk_add_f32 v[34:35], v[34:35], v[42:43]
    v_pk_add_f32 v[36:37], v[36:37], v[44:45]
    v_pk_add_f32 v[38:39], v[38:39], v[46:47]
    v_pk_add_f32 v[32:33], v[32:33], s[72:73]
    v_pk_add_f32 v[34:35], v[34:35], s[72:73]
    v_pk_add_f32 v[36:37], v[36:37], s[72:73]
    v_pk_add_f32 v[38:39], v[38:39], s[72:73]
    v_cvt_pk_bf16_f32 v16, v32, v33
    v_cvt_pk_bf16_f32 v17, v34, v35
    v_cvt_pk_bf16_f32 v18, v36, v37
    v_cvt_pk_bf16_f32 v19, v38, v39
    ds_write_b128 v2, v[16:19] offset:16384
    v_min_f32 v32, 0, v88
    v_min_f32 v33, 0, v89
    v_min_f32 v34, 0, v90
    v_min_f32 v35, 0, v91
    v_min_f32 v36, 0, v92
    v_min_f32 v37, 0, v93
    v_min_f32 v38, 0, v94
    v_min_f32 v39, 0, v95
    v_pk_mul_f32 v[32:33], v[32:33], s[70:71]
    v_pk_mul_f32 v[34:35], v[34:35], s[70:71]
    v_pk_mul_f32 v[36:37], v[36:37], s[70:71]
    v_pk_mul_f32 v[38:39], v[38:39], s[70:71]
    v_exp_f32 v32, v32
    v_exp_f32 v33, v33
    v_exp_f32 v34, v34
    v_exp_f32 v35, v35
    v_exp_f32 v36, v36
    v_exp_f32 v37, v37
    v_exp_f32 v38, v38
    v_exp_f32 v39, v39
    v_max_f32 v40, 0, v88
    v_max_f32 v41, 0, v89
    v_max_f32 v42, 0, v90
    v_max_f32 v43, 0, v91
    v_max_f32 v44, 0, v92
    v_max_f32 v45, 0, v93
    v_max_f32 v46, 0, v94
    v_max_f32 v47, 0, v95
    v_pk_add_f32 v[32:33], v[32:33], v[40:41]
    v_pk_add_f32 v[34:35], v[34:35], v[42:43]
    v_pk_add_f32 v[36:37], v[36:37], v[44:45]
    v_pk_add_f32 v[38:39], v[38:39], v[46:47]
    v_pk_add_f32 v[32:33], v[32:33], s[72:73]
    v_pk_add_f32 v[34:35], v[34:35], s[72:73]
    v_pk_add_f32 v[36:37], v[36:37], s[72:73]
    v_pk_add_f32 v[38:39], v[38:39], s[72:73]
    v_cvt_pk_bf16_f32 v20, v32, v33
    v_cvt_pk_bf16_f32 v21, v34, v35
    v_cvt_pk_bf16_f32 v22, v36, v37
    v_cvt_pk_bf16_f32 v23, v38, v39
    ds_write_b128 v2, v[20:23] offset:17408
    v_min_f32 v32, 0, v96
    v_min_f32 v33, 0, v97
    v_min_f32 v34, 0, v98
    v_min_f32 v35, 0, v99
    v_min_f32 v36, 0, v100
    v_min_f32 v37, 0, v101
    v_min_f32 v38, 0, v102
    v_min_f32 v39, 0, v103
    v_pk_mul_f32 v[32:33], v[32:33], s[70:71]
    v_pk_mul_f32 v[34:35], v[34:35], s[70:71]
    v_pk_mul_f32 v[36:37], v[36:37], s[70:71]
    v_pk_mul_f32 v[38:39], v[38:39], s[70:71]
    v_exp_f32 v32, v32
    v_exp_f32 v33, v33
    v_exp_f32 v34, v34
    v_exp_f32 v35, v35
    v_exp_f32 v36, v36
    v_exp_f32 v37, v37
    v_exp_f32 v38, v38
    v_exp_f32 v39, v39
    v_max_f32 v40, 0, v96
    v_max_f32 v41, 0, v97
    v_max_f32 v42, 0, v98
    v_max_f32 v43, 0, v99
    v_max_f32 v44, 0, v100
    v_max_f32 v45, 0, v101
    v_max_f32 v46, 0, v102
    v_max_f32 v47, 0, v103
    v_pk_add_f32 v[32:33], v[32:33], v[40:41]
    v_pk_add_f32 v[34:35], v[34:35], v[42:43]
    v_pk_add_f32 v[36:37], v[36:37], v[44:45]
    v_pk_add_f32 v[38:39], v[38:39], v[46:47]
    v_pk_add_f32 v[32:33], v[32:33], s[72:73]
    v_pk_add_f32 v[34:35], v[34:35], s[72:73]
    v_pk_add_f32 v[36:37], v[36:37], s[72:73]
    v_pk_add_f32 v[38:39], v[38:39], s[72:73]
    v_cvt_pk_bf16_f32 v16, v32, v33
    v_cvt_pk_bf16_f32 v17, v34, v35
    v_cvt_pk_bf16_f32 v18, v36, v37
    v_cvt_pk_bf16_f32 v19, v38, v39
    ds_write_b128 v2, v[16:19] offset:18432
    v_min_f32 v32, 0, v104
    v_min_f32 v33, 0, v105
    v_min_f32 v34, 0, v106
    v_min_f32 v35, 0, v107
    v_min_f32 v36, 0, v108
    v_min_f32 v37, 0, v109
    v_min_f32 v38, 0, v110
    v_min_f32 v39, 0, v111
    v_pk_mul_f32 v[32:33], v[32:33], s[70:71]
    v_pk_mul_f32 v[34:35], v[34:35], s[70:71]
    v_pk_mul_f32 v[36:37], v[36:37], s[70:71]
    v_pk_mul_f32 v[38:39], v[38:39], s[70:71]
    v_exp_f32 v32, v32
    v_exp_f32 v33, v33
    v_exp_f32 v34, v34
    v_exp_f32 v35, v35
    v_exp_f32 v36, v36
    v_exp_f32 v37, v37
    v_exp_f32 v38, v38
    v_exp_f32 v39, v39
    v_max_f32 v40, 0, v104
    v_max_f32 v41, 0, v105
    v_max_f32 v42, 0, v106
    v_max_f32 v43, 0, v107
    v_max_f32 v44, 0, v108
    v_max_f32 v45, 0, v109
    v_max_f32 v46, 0, v110
    v_max_f32 v47, 0, v111
    v_pk_add_f32 v[32:33], v[32:33], v[40:41]
    v_pk_add_f32 v[34:35], v[34:35], v[42:43]
    v_pk_add_f32 v[36:37], v[36:37], v[44:45]
    v_pk_add_f32 v[38:39], v[38:39], v[46:47]
    v_pk_add_f32 v[32:33], v[32:33], s[72:73]
    v_pk_add_f32 v[34:35], v[34:35], s[72:73]
    v_pk_add_f32 v[36:37], v[36:37], s[72:73]
    v_pk_add_f32 v[38:39], v[38:39], s[72:73]
    v_cvt_pk_bf16_f32 v20, v32, v33
    v_cvt_pk_bf16_f32 v21, v34, v35
    v_cvt_pk_bf16_f32 v22, v36, v37
    v_cvt_pk_bf16_f32 v23, v38, v39
    ds_write_b128 v2, v[20:23] offset:19456
    v_min_f32 v32, 0, v112
    v_min_f32 v33, 0, v113
    v_min_f32 v34, 0, v114
    v_min_f32 v35, 0, v115
    v_min_f32 v36, 0, v116
    v_min_f32 v37, 0, v117
    v_min_f32 v38, 0, v118
    v_min_f32 v39, 0, v119
    v_pk_mul_f32 v[32:33], v[32:33], s[70:71]
    v_pk_mul_f32 v[34:35], v[34:35], s[70:71]
    v_pk_mul_f32 v[36:37], v[36:37], s[70:71]
    v_pk_mul_f32 v[38:39], v[38:39], s[70:71]
    v_exp_f32 v32, v32
    v_exp_f32 v33, v33
    v_exp_f32 v34, v34
    v_exp_f32 v35, v35
    v_exp_f32 v36, v36
    v_exp_f32 v37, v37
    v_exp_f32 v38, v38
    v_exp_f32 v39, v39
    v_max_f32 v40, 0, v112
    v_max_f32 v41, 0, v113
    v_max_f32 v42, 0, v114
    v_max_f32 v43, 0, v115
    v_max_f32 v44, 0, v116
    v_max_f32 v45, 0, v117
    v_max_f32 v46, 0, v118
    v_max_f32 v47, 0, v119
    v_pk_add_f32 v[32:33], v[32:33], v[40:41]
    v_pk_add_f32 v[34:35], v[34:35], v[42:43]
    v_pk_add_f32 v[36:37], v[36:37], v[44:45]
    v_pk_add_f32 v[38:39], v[38:39], v[46:47]
    v_pk_add_f32 v[32:33], v[32:33], s[72:73]
    v_pk_add_f32 v[34:35], v[34:35], s[72:73]
    v_pk_add_f32 v[36:37], v[36:37], s[72:73]
    v_pk_add_f32 v[38:39], v[38:39], s[72:73]
    v_cvt_pk_bf16_f32 v16, v32, v33
    v_cvt_pk_bf16_f32 v17, v34, v35
    v_cvt_pk_bf16_f32 v18, v36, v37
    v_cvt_pk_bf16_f32 v19, v38, v39
    ds_write_b128 v2, v[16:19] offset:32768
    v_min_f32 v32, 0, v120
    v_min_f32 v33, 0, v121
    v_min_f32 v34, 0, v122
    v_min_f32 v35, 0, v123
    v_min_f32 v36, 0, v124
    v_min_f32 v37, 0, v125
    v_min_f32 v38, 0, v126
    v_min_f32 v39, 0, v127
    v_pk_mul_f32 v[32:33], v[32:33], s[70:71]
    v_pk_mul_f32 v[34:35], v[34:35], s[70:71]
    v_pk_mul_f32 v[36:37], v[36:37], s[70:71]
    v_pk_mul_f32 v[38:39], v[38:39], s[70:71]
    v_exp_f32 v32, v32
    v_exp_f32 v33, v33
    v_exp_f32 v34, v34
    v_exp_f32 v35, v35
    v_exp_f32 v36, v36
    v_exp_f32 v37, v37
    v_exp_f32 v38, v38
    v_exp_f32 v39, v39
    v_max_f32 v40, 0, v120
    v_max_f32 v41, 0, v121
    v_max_f32 v42, 0, v122
    v_max_f32 v43, 0, v123
    v_max_f32 v44, 0, v124
    v_max_f32 v45, 0, v125
    v_max_f32 v46, 0, v126
    v_max_f32 v47, 0, v127
    v_pk_add_f32 v[32:33], v[32:33], v[40:41]
    v_pk_add_f32 v[34:35], v[34:35], v[42:43]
    v_pk_add_f32 v[36:37], v[36:37], v[44:45]
    v_pk_add_f32 v[38:39], v[38:39], v[46:47]
    v_pk_add_f32 v[32:33], v[32:33], s[72:73]
    v_pk_add_f32 v[34:35], v[34:35], s[72:73]
    v_pk_add_f32 v[36:37], v[36:37], s[72:73]
    v_pk_add_f32 v[38:39], v[38:39], s[72:73]
    v_cvt_pk_bf16_f32 v20, v32, v33
    v_cvt_pk_bf16_f32 v21, v34, v35
    v_cvt_pk_bf16_f32 v22, v36, v37
    v_cvt_pk_bf16_f32 v23, v38, v39
    ds_write_b128 v2, v[20:23] offset:33792
    v_min_f32 v32, 0, v128
    v_min_f32 v33, 0, v129
    v_min_f32 v34, 0, v130
    v_min_f32 v35, 0, v131
    v_min_f32 v36, 0, v132
    v_min_f32 v37, 0, v133
    v_min_f32 v38, 0, v134
    v_min_f32 v39, 0, v135
    v_pk_mul_f32 v[32:33], v[32:33], s[70:71]
    v_pk_mul_f32 v[34:35], v[34:35], s[70:71]
    v_pk_mul_f32 v[36:37], v[36:37], s[70:71]
    v_pk_mul_f32 v[38:39], v[38:39], s[70:71]
    v_exp_f32 v32, v32
    v_exp_f32 v33, v33
    v_exp_f32 v34, v34
    v_exp_f32 v35, v35
    v_exp_f32 v36, v36
    v_exp_f32 v37, v37
    v_exp_f32 v38, v38
    v_exp_f32 v39, v39
    v_max_f32 v40, 0, v128
    v_max_f32 v41, 0, v129
    v_max_f32 v42, 0, v130
    v_max_f32 v43, 0, v131
    v_max_f32 v44, 0, v132
    v_max_f32 v45, 0, v133
    v_max_f32 v46, 0, v134
    v_max_f32 v47, 0, v135
    v_pk_add_f32 v[32:33], v[32:33], v[40:41]
    v_pk_add_f32 v[34:35], v[34:35], v[42:43]
    v_pk_add_f32 v[36:37], v[36:37], v[44:45]
    v_pk_add_f32 v[38:39], v[38:39], v[46:47]
    v_pk_add_f32 v[32:33], v[32:33], s[72:73]
    v_pk_add_f32 v[34:35], v[34:35], s[72:73]
    v_pk_add_f32 v[36:37], v[36:37], s[72:73]
    v_pk_add_f32 v[38:39], v[38:39], s[72:73]
    v_cvt_pk_bf16_f32 v16, v32, v33
    v_cvt_pk_bf16_f32 v17, v34, v35
    v_cvt_pk_bf16_f32 v18, v36, v37
    v_cvt_pk_bf16_f32 v19, v38, v39
    ds_write_b128 v2, v[16:19] offset:34816
    v_min_f32 v32, 0, v136
    v_min_f32 v33, 0, v137
    v_min_f32 v34, 0, v138
    v_min_f32 v35, 0, v139
    v_min_f32 v36, 0, v140
    v_min_f32 v37, 0, v141
    v_min_f32 v38, 0, v142
    v_min_f32 v39, 0, v143
    v_pk_mul_f32 v[32:33], v[32:33], s[70:71]
    v_pk_mul_f32 v[34:35], v[34:35], s[70:71]
    v_pk_mul_f32 v[36:37], v[36:37], s[70:71]
    v_pk_mul_f32 v[38:39], v[38:39], s[70:71]
    v_exp_f32 v32, v32
    v_exp_f32 v33, v33
    v_exp_f32 v34, v34
    v_exp_f32 v35, v35
    v_exp_f32 v36, v36
    v_exp_f32 v37, v37
    v_exp_f32 v38, v38
    v_exp_f32 v39, v39
    v_max_f32 v40, 0, v136
    v_max_f32 v41, 0, v137
    v_max_f32 v42, 0, v138
    v_max_f32 v43, 0, v139
    v_max_f32 v44, 0, v140
    v_max_f32 v45, 0, v141
    v_max_f32 v46, 0, v142
    v_max_f32 v47, 0, v143
    v_pk_add_f32 v[32:33], v[32:33], v[40:41]
    v_pk_add_f32 v[34:35], v[34:35], v[42:43]
    v_pk_add_f32 v[36:37], v[36:37], v[44:45]
    v_pk_add_f32 v[38:39], v[38:39], v[46:47]
    v_pk_add_f32 v[32:33], v[32:33], s[72:73]
    v_pk_add_f32 v[34:35], v[34:35], s[72:73]
    v_pk_add_f32 v[36:37], v[36:37], s[72:73]
    v_pk_add_f32 v[38:39], v[38:39], s[72:73]
    v_cvt_pk_bf16_f32 v20, v32, v33
    v_cvt_pk_bf16_f32 v21, v34, v35
    v_cvt_pk_bf16_f32 v22, v36, v37
    v_cvt_pk_bf16_f32 v23, v38, v39
    ds_write_b128 v2, v[20:23] offset:35840
    s_waitcnt lgkmcnt(0)
kvjoin_38:
    s_barrier
    s_lshl_b32 s36, s24, 2
    s_lshr_b32 s37, 0x2211100, s36
    s_and_b32 s37, s37, 15
    s_lshr_b32 s38, 0x22121010, s36
    s_and_b32 s38, s38, 15
    s_lshl_b32 s39, s37, 14
    s_add_u32 s40, s38, 3
    s_lshl_b32 s40, s40, 14
    v_add_u32 v4, s39, v1
    v_add_u32 v5, s40, v1
    v_mov_b32 v48, 0
    v_mov_b32 v49, 0
    v_mov_b32 v50, 0
    v_mov_b32 v51, 0
    v_mov_b32 v52, 0
    v_mov_b32 v53, 0
    v_mov_b32 v54, 0
    v_mov_b32 v55, 0
    v_mov_b32 v56, 0
    v_mov_b32 v57, 0
    v_mov_b32 v58, 0
    v_mov_b32 v59, 0
    v_mov_b32 v60, 0
    v_mov_b32 v61, 0
    v_mov_b32 v62, 0
    v_mov_b32 v63, 0
    ds_read_b128 v[176:179], v4 offset:0
    ds_read_b128 v[180:183], v5 offset:0
    ds_read_b128 v[184:187], v4 offset:1024
    ds_read_b128 v[188:191], v5 offset:1024
    ds_read_b128 v[192:195], v4 offset:2048
    ds_read_b128 v[196:199], v5 offset:2048
    ds_read_b128 v[200:203], v4 offset:3072
    ds_read_b128 v[204:207], v5 offset:3072
    ds_read_b128 v[208:211], v4 offset:4096
    ds_read_b128 v[212:215], v5 offset:4096
    s_waitcnt lgkmcnt(8)
    v_mfma_f32_32x32x16_bf16 v[48:63], v[176:179], v[180:183], v[48:63]
    ds_read_b128 v[216:219], v4 offset:5120
    ds_read_b128 v[220:223], v5 offset:5120
    s_waitcnt lgkmcnt(8)
    v_mfma_f32_32x32x16_bf16 v[48:63], v[184:187], v[188:191], v[48:63]
    ds_read_b128 v[224:227], v4 offset:6144
    ds_read_b128 v[228:231], v5 offset:6144
    s_waitcnt lgkmcnt(8)
    v_mfma_f32_32x32x16_bf16 v[48:63], v[192:195], v[196:199], v[48:63]
    ds_read_b128 v[232:235], v4 offset:7168
    ds_read_b128 v[236:239], v5 offset:7168
    s_waitcnt lgkmcnt(8)
    v_mfma_f32_32x32x16_bf16 v[48:63], v[200:203], v[204:207], v[48:63]
    ds_read_b128 v[176:179], v4 offset:8192
    ds_read_b128 v[180:183], v5 offset:8192
    s_waitcnt lgkmcnt(8)
    v_mfma_f32_32x32x16_bf16 v[48:63], v[208:211], v[212:215], v[48:63]
    ds_read_b128 v[184:187], v4 offset:9216
    ds_read_b128 v[188:191], v5 offset:9216
    s_waitcnt lgkmcnt(8)
    v_mfma_f32_32x32x16_bf16 v[48:63], v[216:219], v[220:223], v[48:63]
    ds_read_b128 v[192:195], v4 offset:10240
    ds_read_b128 v[196:199], v5 offset:10240
    s_waitcnt lgkmcnt(8)
    v_mfma_f32_32x32x16_bf16 v[48:63], v[224:227], v[228:231], v[48:63]
    ds_read_b128 v[200:203], v4 offset:11264
    ds_read_b128 v[204:207], v5 offset:11264
    s_waitcnt lgkmcnt(8)
    v_mfma_f32_32x32x16_bf16 v[48:63], v[232:235], v[236:239], v[48:63]
    ds_read_b128 v[208:211], v4 offset:12288
    ds_read_b128 v[212:215], v5 offset:12288
    s_waitcnt lgkmcnt(8)
    v_mfma_f32_32x32x16_bf16 v[48:63], v[176:179], v[180:183], v[48:63]
    ds_read_b128 v[216:219], v4 offset:13312
    ds_read_b128 v[220:223], v5 offset:13312
    s_waitcnt lgkmcnt(8)
    v_mfma_f32_32x32x16_bf16 v[48:63], v[184:187], v[188:191], v[48:63]
    ds_read_b128 v[224:227], v4 offset:14336
    ds_read_b128 v[228:231], v5 offset:14336
    s_waitcnt lgkmcnt(8)
    v_mfma_f32_32x32x16_bf16 v[48:63], v[192:195], v[196:199], v[48:63]
    ds_read_b128 v[232:235], v4 offset:15360
    ds_read_b128 v[236:239], v5 offset:15360
    s_waitcnt lgkmcnt(8)
    v_mfma_f32_32x32x16_bf16 v[48:63], v[200:203], v[204:207], v[48:63]
    s_waitcnt lgkmcnt(6)
    v_mfma_f32_32x32x16_bf16 v[48:63], v[208:211], v[212:215], v[48:63]
    s_waitcnt lgkmcnt(4)
    v_mfma_f32_32x32x16_bf16 v[48:63], v[216:219], v[220:223], v[48:63]
    s_waitcnt lgkmcnt(2)
    v_mfma_f32_32x32x16_bf16 v[48:63], v[224:227], v[228:231], v[48:63]
    s_waitcnt lgkmcnt(0)
    v_mfma_f32_32x32x16_bf16 v[48:63], v[232:235], v[236:239], v[48:63]
    s_lshl_b32 s37, s37, 5
    s_lshl_b32 s38, s38, 5
    v_lshrrev_b32 v4, 5, v14
    v_lshlrev_b32 v4, 2, v4
    v_add_u32 v4, s37, v4
    v_and_b32 v5, 31, v14
    v_add_u32 v5, s38, v5
    v_mov_b32 v6, 72
    v_cmp_eq_u32 s[74:75], v6, v5
    s_lshl_b32 s36, s26, 3
    s_add_u32 s36, s36, s25
    s_mul_i32 s36, s36, 5632
    s_add_u32 s36, s36, 21241856
    v_mov_b32 v7, 18
    v_mov_b32 v3, 5632
    v_add_u32 v16, 0, v4
    v_mul_u32_u24 v17, 3641, v16
    v_lshrrev_b32 v17, 16, v17
    v_mul_u32_u24 v17, 18, v17
    v_sub_u32 v17, v5, v17
    v_cmp_gt_u32 vcc, 18, v17
    s_or_b64 vcc, vcc, s[74:75]
    v_cmp_gt_u32 s[76:77], v6, v16
    v_cndmask_b32 v17, v17, v7, s[74:75]
    s_and_b64 vcc, vcc, s[76:77]
    v_mul_u32_u24 v16, 19, v16
    v_add_lshl_u32 v16, v16, v17, 2
    v_cndmask_b32 v16, v3, v16, vcc
    s_nop 7
    v_add_u32 v16, 98304, v16
    ds_write_b32 v16, v48
    v_add_u32 v20, 1, v4
    v_mul_u32_u24 v21, 3641, v20
    v_lshrrev_b32 v21, 16, v21
    v_mul_u32_u24 v21, 18, v21
    v_sub_u32 v21, v5, v21
    v_cmp_gt_u32 vcc, 18, v21
    s_or_b64 vcc, vcc, s[74:75]
    v_cmp_gt_u32 s[76:77], v6, v20
    v_cndmask_b32 v21, v21, v7, s[74:75]
    s_and_b64 vcc, vcc, s[76:77]
    v_mul_u32_u24 v20, 19, v20
    v_add_lshl_u32 v20, v20, v21, 2
    v_cndmask_b32 v20, v3, v20, vcc
    v_add_u32 v20, 98304, v20
    ds_write_b32 v20, v49
    v_add_u32 v24, 2, v4
    v_mul_u32_u24 v25, 3641, v24
    v_lshrrev_b32 v25, 16, v25
    v_mul_u32_u24 v25, 18, v25
    v_sub_u32 v25, v5, v25
    v_cmp_gt_u32 vcc, 18, v25
    s_or_b64 vcc, vcc, s[74:75]
    v_cmp_gt_u32 s[76:77], v6, v24
    v_cndmask_b32 v25, v25, v7, s[74:75]
    s_and_b64 vcc, vcc, s[76:77]
    v_mul_u32_u24 v24, 19, v24
    v_add_lshl_u32 v24, v24, v25, 2
    v_cndmask_b32 v24, v3, v24, vcc
    v_add_u32 v24, 98304, v24
    ds_write_b32 v24, v50
    v_add_u32 v28, 3, v4
    v_mul_u32_u24 v29, 3641, v28
    v_lshrrev_b32 v29, 16, v29
    v_mul_u32_u24 v29, 18, v29
    v_sub_u32 v29, v5, v29
    v_cmp_gt_u32 vcc, 18, v29
    s_or_b64 vcc, vcc, s[74:75]
    v_cmp_gt_u32 s[76:77], v6, v28
    v_cndmask_b32 v29, v29, v7, s[74:75]
    s_and_b64 vcc, vcc, s[76:77]
    v_mul_u32_u24 v28, 19, v28
    v_add_lshl_u32 v28, v28, v29, 2
    v_cndmask_b32 v28, v3, v28, vcc
    v_add_u32 v28, 98304, v28
    ds_write_b32 v28, v51
    v_add_u32 v16, 8, v4
    v_mul_u32_u24 v17, 3641, v16
    v_lshrrev_b32 v17, 16, v17
    v_mul_u32_u24 v17, 18, v17
    v_sub_u32 v17, v5, v17
    v_cmp_gt_u32 vcc, 18, v17
    s_or_b64 vcc, vcc, s[74:75]
    v_cmp_gt_u32 s[76:77], v6, v16
    v_cndmask_b32 v17, v17, v7, s[74:75]
    s_and_b64 vcc, vcc, s[76:77]
    v_mul_u32_u24 v16, 19, v16
    v_add_lshl_u32 v16, v16, v17, 2
    v_cndmask_b32 v16, v3, v16, vcc
    v_add_u32 v16, 98304, v16
    ds_write_b32 v16, v52
    v_add_u32 v20, 9, v4
    v_mul_u32_u24 v21, 3641, v20
    v_lshrrev_b32 v21, 16, v21
    v_mul_u32_u24 v21, 18, v21
    v_sub_u32 v21, v5, v21
    v_cmp_gt_u32 vcc, 18, v21
    s_or_b64 vcc, vcc, s[74:75]
    v_cmp_gt_u32 s[76:77], v6, v20
    v_cndmask_b32 v21, v21, v7, s[74:75]
    s_and_b64 vcc, vcc, s[76:77]
    v_mul_u32_u24 v20, 19, v20
    v_add_lshl_u32 v20, v20, v21, 2
    v_cndmask_b32 v20, v3, v20, vcc
    v_add_u32 v20, 98304, v20
    ds_write_b32 v20, v53
    v_add_u32 v24, 10, v4
    v_mul_u32_u24 v25, 3641, v24
    v_lshrrev_b32 v25, 16, v25
    v_mul_u32_u24 v25, 18, v25
    v_sub_u32 v25, v5, v25
    v_cmp_gt_u32 vcc, 18, v25
    s_or_b64 vcc, vcc, s[74:75]
    v_cmp_gt_u32 s[76:77], v6, v24
    v_cndmask_b32 v25, v25, v7, s[74:75]
    s_and_b64 vcc, vcc, s[76:77]
    v_mul_u32_u24 v24, 19, v24
    v_add_lshl_u32 v24, v24, v25, 2
    v_cndmask_b32 v24, v3, v24, vcc
    v_add_u32 v24, 98304, v24
    ds_write_b32 v24, v54
    v_add_u32 v28, 11, v4
    v_mul_u32_u24 v29, 3641, v28
    v_lshrrev_b32 v29, 16, v29
    v_mul_u32_u24 v29, 18, v29
    v_sub_u32 v29, v5, v29
    v_cmp_gt_u32 vcc, 18, v29
    s_or_b64 vcc, vcc, s[74:75]
    v_cmp_gt_u32 s[76:77], v6, v28
    v_cndmask_b32 v29, v29, v7, s[74:75]
    s_and_b64 vcc, vcc, s[76:77]
    v_mul_u32_u24 v28, 19, v28
    v_add_lshl_u32 v28, v28, v29, 2
    v_cndmask_b32 v28, v3, v28, vcc
    v_add_u32 v28, 98304, v28
    ds_write_b32 v28, v55
    v_add_u32 v16, 16, v4
    v_mul_u32_u24 v17, 3641, v16
    v_lshrrev_b32 v17, 16, v17
    v_mul_u32_u24 v17, 18, v17
    v_sub_u32 v17, v5, v17
    v_cmp_gt_u32 vcc, 18, v17
    s_or_b64 vcc, vcc, s[74:75]
    v_cmp_gt_u32 s[76:77], v6, v16
    v_cndmask_b32 v17, v17, v7, s[74:75]
    s_and_b64 vcc, vcc, s[76:77]
    v_mul_u32_u24 v16, 19, v16
    v_add_lshl_u32 v16, v16, v17, 2
    v_cndmask_b32 v16, v3, v16, vcc
    v_add_u32 v16, 98304, v16
    ds_write_b32 v16, v56
    v_add_u32 v20, 17, v4
    v_mul_u32_u24 v21, 3641, v20
    v_lshrrev_b32 v21, 16, v21
    v_mul_u32_u24 v21, 18, v21
    v_sub_u32 v21, v5, v21
    v_cmp_gt_u32 vcc, 18, v21
    s_or_b64 vcc, vcc, s[74:75]
    v_cmp_gt_u32 s[76:77], v6, v20
    v_cndmask_b32 v21, v21, v7, s[74:75]
    s_and_b64 vcc, vcc, s[76:77]
    v_mul_u32_u24 v20, 19, v20
    v_add_lshl_u32 v20, v20, v21, 2
    v_cndmask_b32 v20, v3, v20, vcc
    v_add_u32 v20, 98304, v20
    ds_write_b32 v20, v57
    v_add_u32 v24, 18, v4
    v_mul_u32_u24 v25, 3641, v24
    v_lshrrev_b32 v25, 16, v25
    v_mul_u32_u24 v25, 18, v25
    v_sub_u32 v25, v5, v25
    v_cmp_gt_u32 vcc, 18, v25
    s_or_b64 vcc, vcc, s[74:75]
    v_cmp_gt_u32 s[76:77], v6, v24
    v_cndmask_b32 v25, v25, v7, s[74:75]
    s_and_b64 vcc, vcc, s[76:77]
    v_mul_u32_u24 v24, 19, v24
    v_add_lshl_u32 v24, v24, v25, 2
    v_cndmask_b32 v24, v3, v24, vcc
    v_add_u32 v24, 98304, v24
    ds_write_b32 v24, v58
    v_add_u32 v28, 19, v4
    v_mul_u32_u24 v29, 3641, v28
    v_lshrrev_b32 v29, 16, v29
    v_mul_u32_u24 v29, 18, v29
    v_sub_u32 v29, v5, v29
    v_cmp_gt_u32 vcc, 18, v29
    s_or_b64 vcc, vcc, s[74:75]
    v_cmp_gt_u32 s[76:77], v6, v28
    v_cndmask_b32 v29, v29, v7, s[74:75]
    s_and_b64 vcc, vcc, s[76:77]
    v_mul_u32_u24 v28, 19, v28
    v_add_lshl_u32 v28, v28, v29, 2
    v_cndmask_b32 v28, v3, v28, vcc
    v_add_u32 v28, 98304, v28
    ds_write_b32 v28, v59
    v_add_u32 v16, 24, v4
    v_mul_u32_u24 v17, 3641, v16
    v_lshrrev_b32 v17, 16, v17
    v_mul_u32_u24 v17, 18, v17
    v_sub_u32 v17, v5, v17
    v_cmp_gt_u32 vcc, 18, v17
    s_or_b64 vcc, vcc, s[74:75]
    v_cmp_gt_u32 s[76:77], v6, v16
    v_cndmask_b32 v17, v17, v7, s[74:75]
    s_and_b64 vcc, vcc, s[76:77]
    v_mul_u32_u24 v16, 19, v16
    v_add_lshl_u32 v16, v16, v17, 2
    v_cndmask_b32 v16, v3, v16, vcc
    v_add_u32 v16, 98304, v16
    ds_write_b32 v16, v60
    v_add_u32 v20, 25, v4
    v_mul_u32_u24 v21, 3641, v20
    v_lshrrev_b32 v21, 16, v21
    v_mul_u32_u24 v21, 18, v21
    v_sub_u32 v21, v5, v21
    v_cmp_gt_u32 vcc, 18, v21
    s_or_b64 vcc, vcc, s[74:75]
    v_cmp_gt_u32 s[76:77], v6, v20
    v_cndmask_b32 v21, v21, v7, s[74:75]
    s_and_b64 vcc, vcc, s[76:77]
    v_mul_u32_u24 v20, 19, v20
    v_add_lshl_u32 v20, v20, v21, 2
    v_cndmask_b32 v20, v3, v20, vcc
    v_add_u32 v20, 98304, v20
    ds_write_b32 v20, v61
    v_add_u32 v24, 26, v4
    v_mul_u32_u24 v25, 3641, v24
    v_lshrrev_b32 v25, 16, v25
    v_mul_u32_u24 v25, 18, v25
    v_sub_u32 v25, v5, v25
    v_cmp_gt_u32 vcc, 18, v25
    s_or_b64 vcc, vcc, s[74:75]
    v_cmp_gt_u32 s[76:77], v6, v24
    v_cndmask_b32 v25, v25, v7, s[74:75]
    s_and_b64 vcc, vcc, s[76:77]
    v_mul_u32_u24 v24, 19, v24
    v_add_lshl_u32 v24, v24, v25, 2
    v_cndmask_b32 v24, v3, v24, vcc
    v_add_u32 v24, 98304, v24
    ds_write_b32 v24, v62
    v_add_u32 v28, 27, v4
    v_mul_u32_u24 v29, 3641, v28
    v_lshrrev_b32 v29, 16, v29
    v_mul_u32_u24 v29, 18, v29
    v_sub_u32 v29, v5, v29
    v_cmp_gt_u32 vcc, 18, v29
    s_or_b64 vcc, vcc, s[74:75]
    v_cmp_gt_u32 s[76:77], v6, v28
    v_cndmask_b32 v29, v29, v7, s[74:75]
    s_and_b64 vcc, vcc, s[76:77]
    v_mul_u32_u24 v28, 19, v28
    v_add_lshl_u32 v28, v28, v29, 2
    v_cndmask_b32 v28, v3, v28, vcc
    v_add_u32 v28, 98304, v28
    ds_write_b32 v28, v63
    s_waitcnt lgkmcnt(0)
    s_barrier
    s_lshl_b32 s37, s24, 10
    v_add_u32 v2, s37, v1
    v_add_u32 v4, 98304, v2
    ds_read_b128 v[16:19], v4
    v_mov_b32 v5, 0x40000000
    v_cmp_gt_u32 vcc, 5472, v2
    s_nop 1
    v_cndmask_b32 v2, v5, v2, vcc
    s_waitcnt lgkmcnt(0)
    buffer_store_dwordx4 v[16:19], v2, s[12:15], s36 offen sc1
    v_mov_b32 v20, 0
    v_mov_b32 v21, 0
    v_mov_b32 v22, 0
    v_mov_b32 v23, 0
    v_lshlrev_b32 v15, 5, v0
    v_add_u32 v15, 147456, v15
    ds_write_b128 v15, v[20:23]
    ds_write_b128 v15, v[20:23] offset:16
    s_waitcnt vmcnt(0) lgkmcnt(0)
    s_barrier
    s_cmp_lg_u32 s24, 7
    s_cbranch_scc1 nsig_39
    s_lshl_b32 s37, s26, 7
    s_add_u32 s37, s37, 45155328
    v_mov_b32 v16, 1
    v_mov_b32 v17, 0
    s_mov_b64 exec, 1
    buffer_atomic_add v16, v17, s[12:15], s37 offen
    s_mov_b32 s88, 0
kvp_40:
    buffer_load_dword v16, v17, s[12:15], s37 offen sc1
    s_waitcnt vmcnt(0)
    v_readfirstlane_b32 s38, v16
    s_add_u32 s88, s88, 1
    s_cmp_ge_u32 s38, 8
    s_cbranch_scc1 kvd_41
    s_sleep 2
    s_cmp_lt_u32 s88, 0x40000
    s_cbranch_scc1 kvp_40
kvd_41:
    s_mov_b64 exec, -1
nsig_39:
    s_cmp_ge_u32 s24, 4
    s_cbranch_scc1 noq_42
    v_min_f32 v48, 0, v80
    v_min_f32 v49, 0, v81
    v_min_f32 v50, 0, v82
    v_min_f32 v51, 0, v83
    v_min_f32 v52, 0, v84
    v_min_f32 v53, 0, v85
    v_min_f32 v54, 0, v86
    v_min_f32 v55, 0, v87
    v_pk_mul_f32 v[48:49], v[48:49], s[70:71]
    v_pk_mul_f32 v[50:51], v[50:51], s[70:71]
    v_pk_mul_f32 v[52:53], v[52:53], s[70:71]
    v_pk_mul_f32 v[54:55], v[54:55], s[70:71]
    v_exp_f32 v48, v48
    v_exp_f32 v49, v49
    v_exp_f32 v50, v50
    v_exp_f32 v51, v51
    v_exp_f32 v52, v52
    v_exp_f32 v53, v53
    v_exp_f32 v54, v54
    v_exp_f32 v55, v55
    v_max_f32 v56, 0, v80
    v_max_f32 v57, 0, v81
    v_max_f32 v58, 0, v82
    v_max_f32 v59, 0, v83
    v_max_f32 v60, 0, v84
    v_max_f32 v61, 0, v85
    v_max_f32 v62, 0, v86
    v_max_f32 v63, 0, v87
    v_pk_add_f32 v[48:49], v[48:49], v[56:57]
    v_pk_add_f32 v[50:51], v[50:51], v[58:59]
    v_pk_add_f32 v[52:53], v[52:53], v[60:61]
    v_pk_add_f32 v[54:55], v[54:55], v[62:63]
    v_pk_add_f32 v[48:49], v[48:49], s[72:73]
    v_pk_add_f32 v[50:51], v[50:51], s[72:73]
    v_pk_add_f32 v[52:53], v[52:53], s[72:73]
    v_pk_add_f32 v[54:55], v[54:55], s[72:73]
    v_cvt_pk_bf16_f32 v176, v48, v49
    v_cvt_pk_bf16_f32 v177, v50, v51
    v_cvt_pk_bf16_f32 v178, v52, v53
    v_cvt_pk_bf16_f32 v179, v54, v55
    v_min_f32 v48, 0, v88
    v_min_f32 v49, 0, v89
    v_min_f32 v50, 0, v90
    v_min_f32 v51, 0, v91
    v_min_f32 v52, 0, v92
    v_min_f32 v53, 0, v93
    v_min_f32 v54, 0, v94
    v_min_f32 v55, 0, v95
    v_pk_mul_f32 v[48:49], v[48:49], s[70:71]
    v_pk_mul_f32 v[50:51], v[50:51], s[70:71]
    v_pk_mul_f32 v[52:53], v[52:53], s[70:71]
    v_pk_mul_f32 v[54:55], v[54:55], s[70:71]
    v_exp_f32 v48, v48
    v_exp_f32 v49, v49
    v_exp_f32 v50, v50
    v_exp_f32 v51, v51
    v_exp_f32 v52, v52
    v_exp_f32 v53, v53
    v_exp_f32 v54, v54
    v_exp_f32 v55, v55
    v_max_f32 v56, 0, v88
    v_max_f32 v57, 0, v89
    v_max_f32 v58, 0, v90
    v_max_f32 v59, 0, v91
    v_max_f32 v60, 0, v92
    v_max_f32 v61, 0, v93
    v_max_f32 v62, 0, v94
    v_max_f32 v63, 0, v95
    v_pk_add_f32 v[48:49], v[48:49], v[56:57]
    v_pk_add_f32 v[50:51], v[50:51], v[58:59]
    v_pk_add_f32 v[52:53], v[52:53], v[60:61]
    v_pk_add_f32 v[54:55], v[54:55], v[62:63]
    v_pk_add_f32 v[48:49], v[48:49], s[72:73]
    v_pk_add_f32 v[50:51], v[50:51], s[72:73]
    v_pk_add_f32 v[52:53], v[52:53], s[72:73]
    v_pk_add_f32 v[54:55], v[54:55], s[72:73]
    v_cvt_pk_bf16_f32 v180, v48, v49
    v_cvt_pk_bf16_f32 v181, v50, v51
    v_cvt_pk_bf16_f32 v182, v52, v53
    v_cvt_pk_bf16_f32 v183, v54, v55
    v_min_f32 v48, 0, v112
    v_min_f32 v49, 0, v113
    v_min_f32 v50, 0, v114
    v_min_f32 v51, 0, v115
    v_min_f32 v52, 0, v116
    v_min_f32 v53, 0, v117
    v_min_f32 v54, 0, v118
    v_min_f32 v55, 0, v119
    v_pk_mul_f32 v[48:49], v[48:49], s[70:71]
    v_pk_mul_f32 v[50:51], v[50:51], s[70:71]
    v_pk_mul_f32 v[52:53], v[52:53], s[70:71]
    v_pk_mul_f32 v[54:55], v[54:55], s[70:71]
    v_exp_f32 v48, v48
    v_exp_f32 v49, v49
    v_exp_f32 v50, v50
    v_exp_f32 v51, v51
    v_exp_f32 v52, v52
    v_exp_f32 v53, v53
    v_exp_f32 v54, v54
    v_exp_f32 v55, v55
    v_max_f32 v56, 0, v112
    v_max_f32 v57, 0, v113
    v_max_f32 v58, 0, v114
    v_max_f32 v59, 0, v115
    v_max_f32 v60, 0, v116
    v_max_f32 v61, 0, v117
    v_max_f32 v62, 0, v118
    v_max_f32 v63, 0, v119
    v_pk_add_f32 v[48:49], v[48:49], v[56:57]
    v_pk_add_f32 v[50:51], v[50:51], v[58:59]
    v_pk_add_f32 v[52:53], v[52:53], v[60:61]
    v_pk_add_f32 v[54:55], v[54:55], v[62:63]
    v_pk_add_f32 v[48:49], v[48:49], s[72:73]
    v_pk_add_f32 v[50:51], v[50:51], s[72:73]
    v_pk_add_f32 v[52:53], v[52:53], s[72:73]
    v_pk_add_f32 v[54:55], v[54:55], s[72:73]
    v_cvt_pk_bf16_f32 v184, v48, v49
    v_cvt_pk_bf16_f32 v185, v50, v51
    v_cvt_pk_bf16_f32 v186, v52, v53
    v_cvt_pk_bf16_f32 v187, v54, v55
    v_min_f32 v48, 0, v120
    v_min_f32 v49, 0, v121
    v_min_f32 v50, 0, v122
    v_min_f32 v51, 0, v123
    v_min_f32 v52, 0, v124
    v_min_f32 v53, 0, v125
    v_min_f32 v54, 0, v126
    v_min_f32 v55, 0, v127
    v_pk_mul_f32 v[48:49], v[48:49], s[70:71]
    v_pk_mul_f32 v[50:51], v[50:51], s[70:71]
    v_pk_mul_f32 v[52:53], v[52:53], s[70:71]
    v_pk_mul_f32 v[54:55], v[54:55], s[70:71]
    v_exp_f32 v48, v48
    v_exp_f32 v49, v49
    v_exp_f32 v50, v50
    v_exp_f32 v51, v51
    v_exp_f32 v52, v52
    v_exp_f32 v53, v53
    v_exp_f32 v54, v54
    v_exp_f32 v55, v55
    v_max_f32 v56, 0, v120
    v_max_f32 v57, 0, v121
    v_max_f32 v58, 0, v122
    v_max_f32 v59, 0, v123
    v_max_f32 v60, 0, v124
    v_max_f32 v61, 0, v125
    v_max_f32 v62, 0, v126
    v_max_f32 v63, 0, v127
    v_pk_add_f32 v[48:49], v[48:49], v[56:57]
    v_pk_add_f32 v[50:51], v[50:51], v[58:59]
    v_pk_add_f32 v[52:53], v[52:53], v[60:61]
    v_pk_add_f32 v[54:55], v[54:55], v[62:63]
    v_pk_add_f32 v[48:49], v[48:49], s[72:73]
    v_pk_add_f32 v[50:51], v[50:51], s[72:73]
    v_pk_add_f32 v[52:53], v[52:53], s[72:73]
    v_pk_add_f32 v[54:55], v[54:55], s[72:73]
    v_cvt_pk_bf16_f32 v188, v48, v49
    v_cvt_pk_bf16_f32 v189, v50, v51
    v_cvt_pk_bf16_f32 v190, v52, v53
    v_cvt_pk_bf16_f32 v191, v54, v55
    v_min_f32 v48, 0, v144
    v_min_f32 v49, 0, v145
    v_min_f32 v50, 0, v146
    v_min_f32 v51, 0, v147
    v_min_f32 v52, 0, v148
    v_min_f32 v53, 0, v149
    v_min_f32 v54, 0, v150
    v_min_f32 v55, 0, v151
    v_pk_mul_f32 v[48:49], v[48:49], s[70:71]
    v_pk_mul_f32 v[50:51], v[50:51], s[70:71]
    v_pk_mul_f32 v[52:53], v[52:53], s[70:71]
    v_pk_mul_f32 v[54:55], v[54:55], s[70:71]
    v_exp_f32 v48, v48
    v_exp_f32 v49, v49
    v_exp_f32 v50, v50
    v_exp_f32 v51, v51
    v_exp_f32 v52, v52
    v_exp_f32 v53, v53
    v_exp_f32 v54, v54
    v_exp_f32 v55, v55
    v_max_f32 v56, 0, v144
    v_max_f32 v57, 0, v145
    v_max_f32 v58, 0, v146
    v_max_f32 v59, 0, v147
    v_max_f32 v60, 0, v148
    v_max_f32 v61, 0, v149
    v_max_f32 v62, 0, v150
    v_max_f32 v63, 0, v151
    v_pk_add_f32 v[48:49], v[48:49], v[56:57]
    v_pk_add_f32 v[50:51], v[50:51], v[58:59]
    v_pk_add_f32 v[52:53], v[52:53], v[60:61]
    v_pk_add_f32 v[54:55], v[54:55], v[62:63]
    v_pk_add_f32 v[48:49], v[48:49], s[72:73]
    v_pk_add_f32 v[50:51], v[50:51], s[72:73]
    v_pk_add_f32 v[52:53], v[52:53], s[72:73]
    v_pk_add_f32 v[54:55], v[54:55], s[72:73]
    v_cvt_pk_bf16_f32 v192, v48, v49
    v_cvt_pk_bf16_f32 v193, v50, v51
    v_cvt_pk_bf16_f32 v194, v52, v53
    v_cvt_pk_bf16_f32 v195, v54, v55
    v_mov_b32 v194, 0
    v_mov_b32 v195, 0
    v_min_f32 v48, 0, v96
    v_min_f32 v49, 0, v97
    v_min_f32 v50, 0, v98
    v_min_f32 v51, 0, v99
    v_min_f32 v52, 0, v100
    v_min_f32 v53, 0, v101
    v_min_f32 v54, 0, v102
    v_min_f32 v55, 0, v103
    v_pk_mul_f32 v[48:49], v[48:49], s[70:71]
    v_pk_mul_f32 v[50:51], v[50:51], s[70:71]
    v_pk_mul_f32 v[52:53], v[52:53], s[70:71]
    v_pk_mul_f32 v[54:55], v[54:55], s[70:71]
    v_exp_f32 v48, v48
    v_exp_f32 v49, v49
    v_exp_f32 v50, v50
    v_exp_f32 v51, v51
    v_exp_f32 v52, v52
    v_exp_f32 v53, v53
    v_exp_f32 v54, v54
    v_exp_f32 v55, v55
    v_max_f32 v56, 0, v96
    v_max_f32 v57, 0, v97
    v_max_f32 v58, 0, v98
    v_max_f32 v59, 0, v99
    v_max_f32 v60, 0, v100
    v_max_f32 v61, 0, v101
    v_max_f32 v62, 0, v102
    v_max_f32 v63, 0, v103
    v_pk_add_f32 v[48:49], v[48:49], v[56:57]
    v_pk_add_f32 v[50:51], v[50:51], v[58:59]
    v_pk_add_f32 v[52:53], v[52:53], v[60:61]
    v_pk_add_f32 v[54:55], v[54:55], v[62:63]
    v_pk_add_f32 v[48:49], v[48:49], s[72:73]
    v_pk_add_f32 v[50:51], v[50:51], s[72:73]
    v_pk_add_f32 v[52:53], v[52:53], s[72:73]
    v_pk_add_f32 v[54:55], v[54:55], s[72:73]
    v_cvt_pk_bf16_f32 v196, v48, v49
    v_cvt_pk_bf16_f32 v197, v50, v51
    v_cvt_pk_bf16_f32 v198, v52, v53
    v_cvt_pk_bf16_f32 v199, v54, v55
    v_min_f32 v48, 0, v104
    v_min_f32 v49, 0, v105
    v_min_f32 v50, 0, v106
    v_min_f32 v51, 0, v107
    v_min_f32 v52, 0, v108
    v_min_f32 v53, 0, v109
    v_min_f32 v54, 0, v110
    v_min_f32 v55, 0, v111
    v_pk_mul_f32 v[48:49], v[48:49], s[70:71]
    v_pk_mul_f32 v[50:51], v[50:51], s[70:71]
    v_pk_mul_f32 v[52:53], v[52:53], s[70:71]
    v_pk_mul_f32 v[54:55], v[54:55], s[70:71]
    v_exp_f32 v48, v48
    v_exp_f32 v49, v49
    v_exp_f32 v50, v50
    v_exp_f32 v51, v51
    v_exp_f32 v52, v52
    v_exp_f32 v53, v53
    v_exp_f32 v54, v54
    v_exp_f32 v55, v55
    v_max_f32 v56, 0, v104
    v_max_f32 v57, 0, v105
    v_max_f32 v58, 0, v106
    v_max_f32 v59, 0, v107
    v_max_f32 v60, 0, v108
    v_max_f32 v61, 0, v109
    v_max_f32 v62, 0, v110
    v_max_f32 v63, 0, v111
    v_pk_add_f32 v[48:49], v[48:49], v[56:57]
    v_pk_add_f32 v[50:51], v[50:51], v[58:59]
    v_pk_add_f32 v[52:53], v[52:53], v[60:61]
    v_pk_add_f32 v[54:55], v[54:55], v[62:63]
    v_pk_add_f32 v[48:49], v[48:49], s[72:73]
    v_pk_add_f32 v[50:51], v[50:51], s[72:73]
    v_pk_add_f32 v[52:53], v[52:53], s[72:73]
    v_pk_add_f32 v[54:55], v[54:55], s[72:73]
    v_cvt_pk_bf16_f32 v200, v48, v49
    v_cvt_pk_bf16_f32 v201, v50, v51
    v_cvt_pk_bf16_f32 v202, v52, v53
    v_cvt_pk_bf16_f32 v203, v54, v55
    v_min_f32 v48, 0, v128
    v_min_f32 v49, 0, v129
    v_min_f32 v50, 0, v130
    v_min_f32 v51, 0, v131
    v_min_f32 v52, 0, v132
    v_min_f32 v53, 0, v133
    v_min_f32 v54, 0, v134
    v_min_f32 v55, 0, v135
    v_pk_mul_f32 v[48:49], v[48:49], s[70:71]
    v_pk_mul_f32 v[50:51], v[50:51], s[70:71]
    v_pk_mul_f32 v[52:53], v[52:53], s[70:71]
    v_pk_mul_f32 v[54:55], v[54:55], s[70:71]
    v_exp_f32 v48, v48
    v_exp_f32 v49, v49
    v_exp_f32 v50, v50
    v_exp_f32 v51, v51
    v_exp_f32 v52, v52
    v_exp_f32 v53, v53
    v_exp_f32 v54, v54
    v_exp_f32 v55, v55
    v_max_f32 v56, 0, v128
    v_max_f32 v57, 0, v129
    v_max_f32 v58, 0, v130
    v_max_f32 v59, 0, v131
    v_max_f32 v60, 0, v132
    v_max_f32 v61, 0, v133
    v_max_f32 v62, 0, v134
    v_max_f32 v63, 0, v135
    v_pk_add_f32 v[48:49], v[48:49], v[56:57]
    v_pk_add_f32 v[50:51], v[50:51], v[58:59]
    v_pk_add_f32 v[52:53], v[52:53], v[60:61]
    v_pk_add_f32 v[54:55], v[54:55], v[62:63]
    v_pk_add_f32 v[48:49], v[48:49], s[72:73]
    v_pk_add_f32 v[50:51], v[50:51], s[72:73]
    v_pk_add_f32 v[52:53], v[52:53], s[72:73]
    v_pk_add_f32 v[54:55], v[54:55], s[72:73]
    v_cvt_pk_bf16_f32 v204, v48, v49
    v_cvt_pk_bf16_f32 v205, v50, v51
    v_cvt_pk_bf16_f32 v206, v52, v53
    v_cvt_pk_bf16_f32 v207, v54, v55
    v_min_f32 v48, 0, v136
    v_min_f32 v49, 0, v137
    v_min_f32 v50, 0, v138
    v_min_f32 v51, 0, v139
    v_min_f32 v52, 0, v140
    v_min_f32 v53, 0, v141
    v_min_f32 v54, 0, v142
    v_min_f32 v55, 0, v143
    v_pk_mul_f32 v[48:49], v[48:49], s[70:71]
    v_pk_mul_f32 v[50:51], v[50:51], s[70:71]
    v_pk_mul_f32 v[52:53], v[52:53], s[70:71]
    v_pk_mul_f32 v[54:55], v[54:55], s[70:71]
    v_exp_f32 v48, v48
    v_exp_f32 v49, v49
    v_exp_f32 v50, v50
    v_exp_f32 v51, v51
    v_exp_f32 v52, v52
    v_exp_f32 v53, v53
    v_exp_f32 v54, v54
    v_exp_f32 v55, v55
    v_max_f32 v56, 0, v136
    v_max_f32 v57, 0, v137
    v_max_f32 v58, 0, v138
    v_max_f32 v59, 0, v139
    v_max_f32 v60, 0, v140
    v_max_f32 v61, 0, v141
    v_max_f32 v62, 0, v142
    v_max_f32 v63, 0, v143
    v_pk_add_f32 v[48:49], v[48:49], v[56:57]
    v_pk_add_f32 v[50:51], v[50:51], v[58:59]
    v_pk_add_f32 v[52:53], v[52:53], v[60:61]
    v_pk_add_f32 v[54:55], v[54:55], v[62:63]
    v_pk_add_f32 v[48:49], v[48:49], s[72:73]
    v_pk_add_f32 v[50:51], v[50:51], s[72:73]
    v_pk_add_f32 v[52:53], v[52:53], s[72:73]
    v_pk_add_f32 v[54:55], v[54:55], s[72:73]
    v_cvt_pk_bf16_f32 v208, v48, v49
    v_cvt_pk_bf16_f32 v209, v50, v51
    v_cvt_pk_bf16_f32 v210, v52, v53
    v_cvt_pk_bf16_f32 v211, v54, v55
    v_min_f32 v48, 0, v160
    v_min_f32 v49, 0, v161
    v_min_f32 v50, 0, v162
    v_min_f32 v51, 0, v163
    v_min_f32 v52, 0, v164
    v_min_f32 v53, 0, v165
    v_min_f32 v54, 0, v166
    v_min_f32 v55, 0, v167
    v_pk_mul_f32 v[48:49], v[48:49], s[70:71]
    v_pk_mul_f32 v[50:51], v[50:51], s[70:71]
    v_pk_mul_f32 v[52:53], v[52:53], s[70:71]
    v_pk_mul_f32 v[54:55], v[54:55], s[70:71]
    v_exp_f32 v48, v48
    v_exp_f32 v49, v49
    v_exp_f32 v50, v50
    v_exp_f32 v51, v51
    v_exp_f32 v52, v52
    v_exp_f32 v53, v53
    v_exp_f32 v54, v54
    v_exp_f32 v55, v55
    v_max_f32 v56, 0, v160
    v_max_f32 v57, 0, v161
    v_max_f32 v58, 0, v162
    v_max_f32 v59, 0, v163
    v_max_f32 v60, 0, v164
    v_max_f32 v61, 0, v165
    v_max_f32 v62, 0, v166
    v_max_f32 v63, 0, v167
    v_pk_add_f32 v[48:49], v[48:49], v[56:57]
    v_pk_add_f32 v[50:51], v[50:51], v[58:59]
    v_pk_add_f32 v[52:53], v[52:53], v[60:61]
    v_pk_add_f32 v[54:55], v[54:55], v[62:63]
    v_pk_add_f32 v[48:49], v[48:49], s[72:73]
    v_pk_add_f32 v[50:51], v[50:51], s[72:73]
    v_pk_add_f32 v[52:53], v[52:53], s[72:73]
    v_pk_add_f32 v[54:55], v[54:55], s[72:73]
    v_cvt_pk_bf16_f32 v212, v48, v49
    v_cvt_pk_bf16_f32 v213, v50, v51
    v_cvt_pk_bf16_f32 v214, v52, v53
    v_cvt_pk_bf16_f32 v215, v54, v55
    v_mov_b32 v214, 0
    v_mov_b32 v215, 0
    s_cmp_eq_u32 s86, 0
    s_cbranch_scc1 noq_42
    v_mov_b32 v74, v72
    s_nop 1
    v_permlane32_swap_b32 v72, v74
    s_nop 1
    v_add_f32 v46, v72, v74
    v_mul_f32 v46, s70, v46
    v_sub_f32 v46, 0, v46
    v_exp_f32 v46, v46
    s_nop 0
    v_add_f32 v46, 1.0, v46
    v_rcp_f32 v46, v46
    s_lshl_b32 s36, s25, 8
    s_lshl_b32 s37, s26, 5
    s_add_u32 s36, s36, s37
    s_lshl_b32 s36, s36, 2
    s_add_u32 s36, s36, 21233664
    v_and_b32 v15, 31, v14
    v_lshlrev_b32 v15, 2, v15
    buffer_store_dword v46, v15, s[12:15], s36 offen sc1
noq_42:
    v_mov_b32 v7, 18
    v_lshlrev_b32 v216, 2, v0
    v_mul_u32_u24 v217, 3450, v216
    v_lshrrev_b32 v217, 16, v217
    v_mul_u32_u24 v218, 19, v217
    v_sub_u32 v218, v216, v218
    v_mul_u32_u24 v219, 3641, v217
    v_lshrrev_b32 v219, 16, v219
    v_mul_u32_u24 v220, 18, v219
    v_add_u32 v220, v220, v218
    v_add_u32 v219, 72, v219
    v_cmp_eq_u32 s[74:75], v7, v218
    s_nop 1
    v_cndmask_b32 v219, v220, v219, s[74:75]
    v_lshrrev_b32 v220, 5, v219
    v_mul_u32_u24 v220, 5, v220
    v_lshrrev_b32 v221, 4, v217
    v_add_lshl_u32 v220, v220, v221, 6
    v_and_b32 v221, 31, v219
    v_add_u32 v220, v220, v221
    v_bfe_u32 v221, v217, 2, 1
    v_lshl_add_u32 v220, v221, 5, v220
    v_lshlrev_b32 v220, 4, v220
    v_bfe_u32 v221, v217, 3, 1
    v_lshl_add_u32 v220, v221, 3, v220
    v_and_b32 v221, 3, v217
    v_lshl_add_u32 v220, v221, 1, v220
    v_add_u32 v220, 147456, v220
    v_lshl_add_u32 v224, v0, 2, 1
    v_mul_u32_u24 v225, 3450, v224
    v_lshrrev_b32 v225, 16, v225
    v_mul_u32_u24 v226, 19, v225
    v_sub_u32 v226, v224, v226
    v_mul_u32_u24 v227, 3641, v225
    v_lshrrev_b32 v227, 16, v227
    v_mul_u32_u24 v228, 18, v227
    v_add_u32 v228, v228, v226
    v_add_u32 v227, 72, v227
    v_cmp_eq_u32 s[76:77], v7, v226
    s_nop 1
    v_cndmask_b32 v227, v228, v227, s[76:77]
    v_lshrrev_b32 v228, 5, v227
    v_mul_u32_u24 v228, 5, v228
    v_lshrrev_b32 v229, 4, v225
    v_add_lshl_u32 v228, v228, v229, 6
    v_and_b32 v229, 31, v227
    v_add_u32 v228, v228, v229
    v_bfe_u32 v229, v225, 2, 1
    v_lshl_add_u32 v228, v229, 5, v228
    v_lshlrev_b32 v228, 4, v228
    v_bfe_u32 v229, v225, 3, 1
    v_lshl_add_u32 v228, v229, 3, v228
    v_and_b32 v229, 3, v225
    v_lshl_add_u32 v228, v229, 1, v228
    v_add_u32 v228, 147456, v228
    v_lshl_add_u32 v232, v0, 2, 2
    v_mul_u32_u24 v233, 3450, v232
    v_lshrrev_b32 v233, 16, v233
    v_mul_u32_u24 v234, 19, v233
    v_sub_u32 v234, v232, v234
    v_mul_u32_u24 v235, 3641, v233
    v_lshrrev_b32 v235, 16, v235
    v_mul_u32_u24 v236, 18, v235
    v_add_u32 v236, v236, v234
    v_add_u32 v235, 72, v235
    v_cmp_eq_u32 s[78:79], v7, v234
    s_nop 1
    v_cndmask_b32 v235, v236, v235, s[78:79]
    v_lshrrev_b32 v236, 5, v235
    v_mul_u32_u24 v236, 5, v236
    v_lshrrev_b32 v237, 4, v233
    v_add_lshl_u32 v236, v236, v237, 6
    v_and_b32 v237, 31, v235
    v_add_u32 v236, v236, v237
    v_bfe_u32 v237, v233, 2, 1
    v_lshl_add_u32 v236, v237, 5, v236
    v_lshlrev_b32 v236, 4, v236
    v_bfe_u32 v237, v233, 3, 1
    v_lshl_add_u32 v236, v237, 3, v236
    v_and_b32 v237, 3, v233
    v_lshl_add_u32 v236, v237, 1, v236
    v_add_u32 v236, 147456, v236
    v_lshl_add_u32 v240, v0, 2, 3
    v_mul_u32_u24 v241, 3450, v240
    v_lshrrev_b32 v241, 16, v241
    v_mul_u32_u24 v242, 19, v241
    v_sub_u32 v242, v240, v242
    v_mul_u32_u24 v243, 3641, v241
    v_lshrrev_b32 v243, 16, v243
    v_mul_u32_u24 v244, 18, v243
    v_add_u32 v244, v244, v242
    v_add_u32 v243, 72, v243
    v_cmp_eq_u32 s[80:81], v7, v242
    s_nop 1
    v_cndmask_b32 v243, v244, v243, s[80:81]
    v_lshrrev_b32 v244, 5, v243
    v_mul_u32_u24 v244, 5, v244
    v_lshrrev_b32 v245, 4, v241
    v_add_lshl_u32 v244, v244, v245, 6
    v_and_b32 v245, 31, v243
    v_add_u32 v244, v244, v245
    v_bfe_u32 v245, v241, 2, 1
    v_lshl_add_u32 v244, v245, 5, v244
    v_lshlrev_b32 v244, 4, v244
    v_bfe_u32 v245, v241, 3, 1
    v_lshl_add_u32 v244, v245, 3, v244
    v_and_b32 v245, 3, v241
    v_lshl_add_u32 v244, v245, 1, v244
    v_add_u32 v244, 147456, v244
    v_lshlrev_b32 v2, 4, v0
    v_mov_b32 v3, 0x40000000
    v_cmp_gt_u32 vcc, 342, v0
    s_nop 1
    v_cndmask_b32 v2, v3, v2, vcc
    s_barrier
    s_mul_i32 s36, s26, 45056
    s_add_u32 s36, s36, 21241856
    buffer_load_dwordx4 v[80:83], v2, s[12:15], s36 offen sc1
    s_add_u32 s36, s36, 5632
    buffer_load_dwordx4 v[84:87], v2, s[12:15], s36 offen sc1
    s_add_u32 s36, s36, 5632
    buffer_load_dwordx4 v[88:91], v2, s[12:15], s36 offen sc1
    s_add_u32 s36, s36, 5632
    buffer_load_dwordx4 v[92:95], v2, s[12:15], s36 offen sc1
    s_add_u32 s36, s36, 5632
    buffer_load_dwordx4 v[96:99], v2, s[12:15], s36 offen sc1
    s_add_u32 s36, s36, 5632
    buffer_load_dwordx4 v[100:103], v2, s[12:15], s36 offen sc1
    s_add_u32 s36, s36, 5632
    buffer_load_dwordx4 v[104:107], v2, s[12:15], s36 offen sc1
    s_add_u32 s36, s36, 5632
    buffer_load_dwordx4 v[108:111], v2, s[12:15], s36 offen sc1
    s_waitcnt vmcnt(0)
    v_pk_add_f32 v[80:81], v[80:81], v[84:85]
    v_pk_add_f32 v[82:83], v[82:83], v[86:87]
    v_pk_add_f32 v[80:81], v[80:81], v[88:89]
    v_pk_add_f32 v[82:83], v[82:83], v[90:91]
    v_pk_add_f32 v[80:81], v[80:81], v[92:93]
    v_pk_add_f32 v[82:83], v[82:83], v[94:95]
    v_pk_add_f32 v[96:97], v[96:97], v[100:101]
    v_pk_add_f32 v[98:99], v[98:99], v[102:103]
    v_pk_add_f32 v[96:97], v[96:97], v[104:105]
    v_pk_add_f32 v[98:99], v[98:99], v[106:107]
    v_pk_add_f32 v[96:97], v[96:97], v[108:109]
    v_pk_add_f32 v[98:99], v[98:99], v[110:111]
    v_pk_add_f32 v[80:81], v[80:81], v[96:97]
    v_pk_add_f32 v[82:83], v[82:83], v[98:99]
    v_cvt_pk_bf16_f32 v80, v80, v80
    v_cvt_pk_bf16_f32 v81, v81, v81
    v_cvt_pk_bf16_f32 v82, v82, v82
    v_cvt_pk_bf16_f32 v83, v83, v83
    s_mov_b64 exec, vcc
    s_cbranch_execz nosc_43
    ds_write_b16 v220, v80
    ds_write_b16 v228, v81
    ds_write_b16 v236, v82
    ds_write_b16 v244, v83
    s_and_b64 exec, vcc, s[74:75]
    ds_write_b16 v220, v80 offset:64
    s_and_b64 exec, vcc, s[76:77]
    ds_write_b16 v228, v81 offset:64
    s_and_b64 exec, vcc, s[78:79]
    ds_write_b16 v236, v82 offset:64
    s_and_b64 exec, vcc, s[80:81]
    ds_write_b16 v244, v83 offset:64
nosc_43:
    s_mov_b64 exec, -1
    s_waitcnt lgkmcnt(0)
    s_barrier
    s_cmp_ge_u32 s24, 4
    s_cbranch_scc1 k2_entry
    v_add_u32 v4, 147456, v1
    ds_read_b128 v[128:131], v4 offset:10240
    ds_read_b128 v[132:135], v4 offset:11264
    ds_read_b128 v[136:139], v4 offset:12288
    ds_read_b128 v[140:143], v4 offset:13312
    ds_read_b128 v[144:147], v4 offset:14336
    ds_read_b128 v[148:151], v4 offset:0
    ds_read_b128 v[152:155], v4 offset:1024
    ds_read_b128 v[156:159], v4 offset:2048
    ds_read_b128 v[160:163], v4 offset:6144
    ds_read_b128 v[164:167], v4 offset:7168
    ds_read_b128 v[168:171], v4 offset:8192
    ds_read_b128 v[172:175], v4 offset:9216
    v_cmp_lt_u32 vcc, 31, v14
    s_mul_i32 s37, s26, 9
    s_lshr_b32 s37, s37, 1
    s_lshl_b32 s38, s25, 3
    s_lshl_b32 s39, s24, 1
    s_add_u32 s38, s38, s39
    s_mul_i32 s38, s38, 324
    s_add_u32 s38, s38, 288
    s_add_u32 s38, s38, s37
    s_lshl_b32 s38, s38, 10
    v_add_u32 v2, s38, v1
    v_add_u32 v3, 4096, v2
    s_waitcnt lgkmcnt(0)
    s_and_b32 s37, s26, 1
    s_cmp_eq_u32 s37, 1
    s_cbranch_scc1 hgodd_45
    v_mfma_f32_32x32x16_bf16 v[112:127], v[128:131], v[176:179], 0
    v_mfma_f32_32x32x16_bf16 v[112:127], v[132:135], v[180:183], v[112:127]
    v_mfma_f32_32x32x16_bf16 v[112:127], v[136:139], v[184:187], v[112:127]
    v_mfma_f32_32x32x16_bf16 v[112:127], v[140:143], v[188:191], v[112:127]
    v_mfma_f32_32x32x16_bf16 v[112:127], v[144:147], v[192:195], v[112:127]
    v_mfma_f32_32x32x16_bf16 v[80:95], v[148:151], v[176:179], 0
    v_mfma_f32_32x32x16_bf16 v[80:95], v[152:155], v[180:183], v[80:95]
    v_mfma_f32_32x32x16_bf16 v[80:95], v[156:159], v[184:187], v[80:95]
    v_mfma_f32_32x32x16_bf16 v[96:111], v[160:163], v[180:183], 0
    v_mfma_f32_32x32x16_bf16 v[96:111], v[164:167], v[184:187], v[96:111]
    v_mfma_f32_32x32x16_bf16 v[96:111], v[168:171], v[188:191], v[96:111]
    v_mfma_f32_32x32x16_bf16 v[96:111], v[172:175], v[192:195], v[96:111]
    s_nop 4
    v_add_f32 v16, s72, v116
    v_add_f32 v17, s72, v117
    v_add_f32 v18, s72, v118
    v_add_f32 v19, s72, v119
    v_rcp_f32 v16, v16
    v_rcp_f32 v17, v17
    v_rcp_f32 v18, v18
    v_rcp_f32 v19, v19
    s_nop 0
    v_cndmask_b32 v20, v16, v17, vcc
    v_cndmask_b32 v21, v17, v18, vcc
    v_cndmask_b32 v22, v18, v19, vcc
    s_nop 3
    v_pk_mul_f32 v[36:37], v[80:81], v[16:17] op_sel_hi:[1,0]
    v_pk_mul_f32 v[38:39], v[82:83], v[16:17] op_sel_hi:[1,0]
    v_cvt_pk_bf16_f32 v24, v36, v37
    v_cvt_pk_bf16_f32 v25, v38, v39
    v_pk_mul_f32 v[40:41], v[84:85], v[16:17] op_sel_hi:[1,0]
    v_pk_mul_f32 v[42:43], v[86:87], v[16:17] op_sel_hi:[1,0]
    v_cvt_pk_bf16_f32 v26, v40, v41
    v_cvt_pk_bf16_f32 v27, v42, v43
    buffer_store_dwordx4 v[24:27], v2, s[12:15], 0 offen offset:0 sc1
    v_pk_mul_f32 v[36:37], v[88:89], v[20:21] op_sel_hi:[1,0]
    v_pk_mul_f32 v[38:39], v[90:91], v[16:17] op_sel:[0,1] op_sel_hi:[1,1]
    v_cvt_pk_bf16_f32 v28, v36, v37
    v_cvt_pk_bf16_f32 v29, v38, v39
    v_pk_mul_f32 v[40:41], v[92:93], v[16:17] op_sel:[0,1] op_sel_hi:[1,1]
    v_pk_mul_f32 v[42:43], v[94:95], v[16:17] op_sel:[0,1] op_sel_hi:[1,1]
    v_cvt_pk_bf16_f32 v30, v40, v41
    v_cvt_pk_bf16_f32 v31, v42, v43
    buffer_store_dwordx4 v[28:31], v2, s[12:15], 0 offen offset:1024 sc1
    v_pk_mul_f32 v[36:37], v[96:97], v[20:21] op_sel:[0,1] op_sel_hi:[1,1]
    v_pk_mul_f32 v[38:39], v[98:99], v[20:21] op_sel:[0,1] op_sel_hi:[1,1]
    v_cvt_pk_bf16_f32 v32, v36, v37
    v_cvt_pk_bf16_f32 v33, v38, v39
    v_pk_mul_f32 v[40:41], v[100:101], v[18:19] op_sel_hi:[1,0]
    v_pk_mul_f32 v[42:43], v[102:103], v[18:19] op_sel_hi:[1,0]
    v_cvt_pk_bf16_f32 v34, v40, v41
    v_cvt_pk_bf16_f32 v35, v42, v43
    buffer_store_dwordx4 v[32:35], v2, s[12:15], 0 offen offset:2048 sc1
    v_pk_mul_f32 v[36:37], v[104:105], v[18:19] op_sel_hi:[1,0]
    v_pk_mul_f32 v[38:39], v[106:107], v[22:23] op_sel_hi:[1,0]
    v_cvt_pk_bf16_f32 v24, v36, v37
    v_cvt_pk_bf16_f32 v25, v38, v39
    v_pk_mul_f32 v[40:41], v[108:109], v[18:19] op_sel:[0,1] op_sel_hi:[1,1]
    v_pk_mul_f32 v[42:43], v[110:111], v[18:19] op_sel:[0,1] op_sel_hi:[1,1]
    v_cvt_pk_bf16_f32 v26, v40, v41
    v_cvt_pk_bf16_f32 v27, v42, v43
    buffer_store_dwordx4 v[24:27], v2, s[12:15], 0 offen offset:3072 sc1
    v_pk_mul_f32 v[36:37], v[112:113], v[18:19] op_sel:[0,1] op_sel_hi:[1,1]
    v_pk_mul_f32 v[38:39], v[114:115], v[18:19] op_sel:[0,1] op_sel_hi:[1,1]
    v_cvt_pk_bf16_f32 v28, v36, v37
    v_cvt_pk_bf16_f32 v29, v38, v39
    buffer_store_dwordx2 v[28:29], v3, s[12:15], 0 offen offset:0 sc1
    v_add_u32 v2, 331776, v2
    v_add_u32 v3, 331776, v3
    v_mfma_f32_32x32x16_bf16 v[112:127], v[128:131], v[196:199], 0
    v_mfma_f32_32x32x16_bf16 v[112:127], v[132:135], v[200:203], v[112:127]
    v_mfma_f32_32x32x16_bf16 v[112:127], v[136:139], v[204:207], v[112:127]
    v_mfma_f32_32x32x16_bf16 v[112:127], v[140:143], v[208:211], v[112:127]
    v_mfma_f32_32x32x16_bf16 v[112:127], v[144:147], v[212:215], v[112:127]
    v_mfma_f32_32x32x16_bf16 v[80:95], v[148:151], v[196:199], 0
    v_mfma_f32_32x32x16_bf16 v[80:95], v[152:155], v[200:203], v[80:95]
    v_mfma_f32_32x32x16_bf16 v[80:95], v[156:159], v[204:207], v[80:95]
    v_mfma_f32_32x32x16_bf16 v[96:111], v[160:163], v[200:203], 0
    v_mfma_f32_32x32x16_bf16 v[96:111], v[164:167], v[204:207], v[96:111]
    v_mfma_f32_32x32x16_bf16 v[96:111], v[168:171], v[208:211], v[96:111]
    v_mfma_f32_32x32x16_bf16 v[96:111], v[172:175], v[212:215], v[96:111]
    s_nop 4
    v_add_f32 v16, s72, v116
    v_add_f32 v17, s72, v117
    v_add_f32 v18, s72, v118
    v_add_f32 v19, s72, v119
    v_rcp_f32 v16, v16
    v_rcp_f32 v17, v17
    v_rcp_f32 v18, v18
    v_rcp_f32 v19, v19
    s_nop 0
    v_cndmask_b32 v20, v16, v17, vcc
    v_cndmask_b32 v21, v17, v18, vcc
    v_cndmask_b32 v22, v18, v19, vcc
    s_nop 3
    v_pk_mul_f32 v[36:37], v[80:81], v[16:17] op_sel_hi:[1,0]
    v_pk_mul_f32 v[38:39], v[82:83], v[16:17] op_sel_hi:[1,0]
    v_cvt_pk_bf16_f32 v24, v36, v37
    v_cvt_pk_bf16_f32 v25, v38, v39
    v_pk_mul_f32 v[40:41], v[84:85], v[16:17] op_sel_hi:[1,0]
    v_pk_mul_f32 v[42:43], v[86:87], v[16:17] op_sel_hi:[1,0]
    v_cvt_pk_bf16_f32 v26, v40, v41
    v_cvt_pk_bf16_f32 v27, v42, v43
    buffer_store_dwordx4 v[24:27], v2, s[12:15], 0 offen offset:0 sc1
    v_pk_mul_f32 v[36:37], v[88:89], v[20:21] op_sel_hi:[1,0]
    v_pk_mul_f32 v[38:39], v[90:91], v[16:17] op_sel:[0,1] op_sel_hi:[1,1]
    v_cvt_pk_bf16_f32 v28, v36, v37
    v_cvt_pk_bf16_f32 v29, v38, v39
    v_pk_mul_f32 v[40:41], v[92:93], v[16:17] op_sel:[0,1] op_sel_hi:[1,1]
    v_pk_mul_f32 v[42:43], v[94:95], v[16:17] op_sel:[0,1] op_sel_hi:[1,1]
    v_cvt_pk_bf16_f32 v30, v40, v41
    v_cvt_pk_bf16_f32 v31, v42, v43
    buffer_store_dwordx4 v[28:31], v2, s[12:15], 0 offen offset:1024 sc1
    v_pk_mul_f32 v[36:37], v[96:97], v[20:21] op_sel:[0,1] op_sel_hi:[1,1]
    v_pk_mul_f32 v[38:39], v[98:99], v[20:21] op_sel:[0,1] op_sel_hi:[1,1]
    v_cvt_pk_bf16_f32 v32, v36, v37
    v_cvt_pk_bf16_f32 v33, v38, v39
    v_pk_mul_f32 v[40:41], v[100:101], v[18:19] op_sel_hi:[1,0]
    v_pk_mul_f32 v[42:43], v[102:103], v[18:19] op_sel_hi:[1,0]
    v_cvt_pk_bf16_f32 v34, v40, v41
    v_cvt_pk_bf16_f32 v35, v42, v43
    buffer_store_dwordx4 v[32:35], v2, s[12:15], 0 offen offset:2048 sc1
    v_pk_mul_f32 v[36:37], v[104:105], v[18:19] op_sel_hi:[1,0]
    v_pk_mul_f32 v[38:39], v[106:107], v[22:23] op_sel_hi:[1,0]
    v_cvt_pk_bf16_f32 v24, v36, v37
    v_cvt_pk_bf16_f32 v25, v38, v39
    v_pk_mul_f32 v[40:41], v[108:109], v[18:19] op_sel:[0,1] op_sel_hi:[1,1]
    v_pk_mul_f32 v[42:43], v[110:111], v[18:19] op_sel:[0,1] op_sel_hi:[1,1]
    v_cvt_pk_bf16_f32 v26, v40, v41
    v_cvt_pk_bf16_f32 v27, v42, v43
    buffer_store_dwordx4 v[24:27], v2, s[12:15], 0 offen offset:3072 sc1
    v_pk_mul_f32 v[36:37], v[112:113], v[18:19] op_sel:[0,1] op_sel_hi:[1,1]
    v_pk_mul_f32 v[38:39], v[114:115], v[18:19] op_sel:[0,1] op_sel_hi:[1,1]
    v_cvt_pk_bf16_f32 v28, v36, v37
    v_cvt_pk_bf16_f32 v29, v38, v39
    buffer_store_dwordx2 v[28:29], v3, s[12:15], 0 offen offset:0 sc1
    s_branch hgend_46
hgodd_45:
    v_mfma_f32_32x32x16_bf16 v[112:127], v[128:131], v[176:179], 0
    v_mfma_f32_32x32x16_bf16 v[112:127], v[132:135], v[180:183], v[112:127]
    v_mfma_f32_32x32x16_bf16 v[112:127], v[136:139], v[184:187], v[112:127]
    v_mfma_f32_32x32x16_bf16 v[112:127], v[140:143], v[188:191], v[112:127]
    v_mfma_f32_32x32x16_bf16 v[112:127], v[144:147], v[192:195], v[112:127]
    v_mfma_f32_32x32x16_bf16 v[80:95], v[148:151], v[176:179], 0
    v_mfma_f32_32x32x16_bf16 v[80:95], v[152:155], v[180:183], v[80:95]
    v_mfma_f32_32x32x16_bf16 v[80:95], v[156:159], v[184:187], v[80:95]
    v_mfma_f32_32x32x16_bf16 v[96:111], v[160:163], v[180:183], 0
    v_mfma_f32_32x32x16_bf16 v[96:111], v[164:167], v[184:187], v[96:111]
    v_mfma_f32_32x32x16_bf16 v[96:111], v[168:171], v[188:191], v[96:111]
    v_mfma_f32_32x32x16_bf16 v[96:111], v[172:175], v[192:195], v[96:111]
    s_nop 4
    v_add_f32 v16, s72, v116
    v_add_f32 v17, s72, v117
    v_add_f32 v18, s72, v118
    v_add_f32 v19, s72, v119
    v_rcp_f32 v16, v16
    v_rcp_f32 v17, v17
    v_rcp_f32 v18, v18
    v_rcp_f32 v19, v19
    s_nop 0
    v_cndmask_b32 v20, v16, v17, vcc
    v_cndmask_b32 v21, v17, v18, vcc
    v_cndmask_b32 v22, v18, v19, vcc
    s_nop 3
    v_pk_mul_f32 v[36:37], v[80:81], v[16:17] op_sel_hi:[1,0]
    v_pk_mul_f32 v[38:39], v[82:83], v[16:17] op_sel_hi:[1,0]
    v_cvt_pk_bf16_f32 v26, v36, v37
    v_cvt_pk_bf16_f32 v27, v38, v39
    buffer_store_dwordx2 v[26:27], v2, s[12:15], 0 offen offset:8 sc1
    v_pk_mul_f32 v[40:41], v[84:85], v[16:17] op_sel_hi:[1,0]
    v_pk_mul_f32 v[42:43], v[86:87], v[16:17] op_sel_hi:[1,0]
    v_cvt_pk_bf16_f32 v28, v40, v41
    v_cvt_pk_bf16_f32 v29, v42, v43
    v_pk_mul_f32 v[36:37], v[88:89], v[20:21] op_sel_hi:[1,0]
    v_pk_mul_f32 v[38:39], v[90:91], v[16:17] op_sel:[0,1] op_sel_hi:[1,1]
    v_cvt_pk_bf16_f32 v30, v36, v37
    v_cvt_pk_bf16_f32 v31, v38, v39
    buffer_store_dwordx4 v[28:31], v2, s[12:15], 0 offen offset:1024 sc1
    v_pk_mul_f32 v[40:41], v[92:93], v[16:17] op_sel:[0,1] op_sel_hi:[1,1]
    v_pk_mul_f32 v[42:43], v[94:95], v[16:17] op_sel:[0,1] op_sel_hi:[1,1]
    v_cvt_pk_bf16_f32 v32, v40, v41
    v_cvt_pk_bf16_f32 v33, v42, v43
    v_pk_mul_f32 v[36:37], v[96:97], v[20:21] op_sel:[0,1] op_sel_hi:[1,1]
    v_pk_mul_f32 v[38:39], v[98:99], v[20:21] op_sel:[0,1] op_sel_hi:[1,1]
    v_cvt_pk_bf16_f32 v34, v36, v37
    v_cvt_pk_bf16_f32 v35, v38, v39
    buffer_store_dwordx4 v[32:35], v2, s[12:15], 0 offen offset:2048 sc1
    v_pk_mul_f32 v[40:41], v[100:101], v[18:19] op_sel_hi:[1,0]
    v_pk_mul_f32 v[42:43], v[102:103], v[18:19] op_sel_hi:[1,0]
    v_cvt_pk_bf16_f32 v24, v40, v41
    v_cvt_pk_bf16_f32 v25, v42, v43
    v_pk_mul_f32 v[36:37], v[104:105], v[18:19] op_sel_hi:[1,0]
    v_pk_mul_f32 v[38:39], v[106:107], v[22:23] op_sel_hi:[1,0]
    v_cvt_pk_bf16_f32 v26, v36, v37
    v_cvt_pk_bf16_f32 v27, v38, v39
    buffer_store_dwordx4 v[24:27], v2, s[12:15], 0 offen offset:3072 sc1
    v_pk_mul_f32 v[40:41], v[108:109], v[18:19] op_sel:[0,1] op_sel_hi:[1,1]
    v_pk_mul_f32 v[42:43], v[110:111], v[18:19] op_sel:[0,1] op_sel_hi:[1,1]
    v_cvt_pk_bf16_f32 v28, v40, v41
    v_cvt_pk_bf16_f32 v29, v42, v43
    v_pk_mul_f32 v[36:37], v[112:113], v[18:19] op_sel:[0,1] op_sel_hi:[1,1]
    v_pk_mul_f32 v[38:39], v[114:115], v[18:19] op_sel:[0,1] op_sel_hi:[1,1]
    v_cvt_pk_bf16_f32 v30, v36, v37
    v_cvt_pk_bf16_f32 v31, v38, v39
    buffer_store_dwordx4 v[28:31], v3, s[12:15], 0 offen offset:0 sc1
    v_add_u32 v2, 331776, v2
    v_add_u32 v3, 331776, v3
    v_mfma_f32_32x32x16_bf16 v[112:127], v[128:131], v[196:199], 0
    v_mfma_f32_32x32x16_bf16 v[112:127], v[132:135], v[200:203], v[112:127]
    v_mfma_f32_32x32x16_bf16 v[112:127], v[136:139], v[204:207], v[112:127]
    v_mfma_f32_32x32x16_bf16 v[112:127], v[140:143], v[208:211], v[112:127]
    v_mfma_f32_32x32x16_bf16 v[112:127], v[144:147], v[212:215], v[112:127]
    v_mfma_f32_32x32x16_bf16 v[80:95], v[148:151], v[196:199], 0
    v_mfma_f32_32x32x16_bf16 v[80:95], v[152:155], v[200:203], v[80:95]
    v_mfma_f32_32x32x16_bf16 v[80:95], v[156:159], v[204:207], v[80:95]
    v_mfma_f32_32x32x16_bf16 v[96:111], v[160:163], v[200:203], 0
    v_mfma_f32_32x32x16_bf16 v[96:111], v[164:167], v[204:207], v[96:111]
    v_mfma_f32_32x32x16_bf16 v[96:111], v[168:171], v[208:211], v[96:111]
    v_mfma_f32_32x32x16_bf16 v[96:111], v[172:175], v[212:215], v[96:111]
    s_nop 4
    v_add_f32 v16, s72, v116
    v_add_f32 v17, s72, v117
    v_add_f32 v18, s72, v118
    v_add_f32 v19, s72, v119
    v_rcp_f32 v16, v16
    v_rcp_f32 v17, v17
    v_rcp_f32 v18, v18
    v_rcp_f32 v19, v19
    s_nop 0
    v_cndmask_b32 v20, v16, v17, vcc
    v_cndmask_b32 v21, v17, v18, vcc
    v_cndmask_b32 v22, v18, v19, vcc
    s_nop 3
    v_pk_mul_f32 v[36:37], v[80:81], v[16:17] op_sel_hi:[1,0]
    v_pk_mul_f32 v[38:39], v[82:83], v[16:17] op_sel_hi:[1,0]
    v_cvt_pk_bf16_f32 v26, v36, v37
    v_cvt_pk_bf16_f32 v27, v38, v39
    buffer_store_dwordx2 v[26:27], v2, s[12:15], 0 offen offset:8 sc1
    v_pk_mul_f32 v[40:41], v[84:85], v[16:17] op_sel_hi:[1,0]
    v_pk_mul_f32 v[42:43], v[86:87], v[16:17] op_sel_hi:[1,0]
    v_cvt_pk_bf16_f32 v28, v40, v41
    v_cvt_pk_bf16_f32 v29, v42, v43
    v_pk_mul_f32 v[36:37], v[88:89], v[20:21] op_sel_hi:[1,0]
    v_pk_mul_f32 v[38:39], v[90:91], v[16:17] op_sel:[0,1] op_sel_hi:[1,1]
    v_cvt_pk_bf16_f32 v30, v36, v37
    v_cvt_pk_bf16_f32 v31, v38, v39
    buffer_store_dwordx4 v[28:31], v2, s[12:15], 0 offen offset:1024 sc1
    v_pk_mul_f32 v[40:41], v[92:93], v[16:17] op_sel:[0,1] op_sel_hi:[1,1]
    v_pk_mul_f32 v[42:43], v[94:95], v[16:17] op_sel:[0,1] op_sel_hi:[1,1]
    v_cvt_pk_bf16_f32 v32, v40, v41
    v_cvt_pk_bf16_f32 v33, v42, v43
    v_pk_mul_f32 v[36:37], v[96:97], v[20:21] op_sel:[0,1] op_sel_hi:[1,1]
    v_pk_mul_f32 v[38:39], v[98:99], v[20:21] op_sel:[0,1] op_sel_hi:[1,1]
    v_cvt_pk_bf16_f32 v34, v36, v37
    v_cvt_pk_bf16_f32 v35, v38, v39
    buffer_store_dwordx4 v[32:35], v2, s[12:15], 0 offen offset:2048 sc1
    v_pk_mul_f32 v[40:41], v[100:101], v[18:19] op_sel_hi:[1,0]
    v_pk_mul_f32 v[42:43], v[102:103], v[18:19] op_sel_hi:[1,0]
    v_cvt_pk_bf16_f32 v24, v40, v41
    v_cvt_pk_bf16_f32 v25, v42, v43
    v_pk_mul_f32 v[36:37], v[104:105], v[18:19] op_sel_hi:[1,0]
    v_pk_mul_f32 v[38:39], v[106:107], v[22:23] op_sel_hi:[1,0]
    v_cvt_pk_bf16_f32 v26, v36, v37
    v_cvt_pk_bf16_f32 v27, v38, v39
    buffer_store_dwordx4 v[24:27], v2, s[12:15], 0 offen offset:3072 sc1
    v_pk_mul_f32 v[40:41], v[108:109], v[18:19] op_sel:[0,1] op_sel_hi:[1,1]
    v_pk_mul_f32 v[42:43], v[110:111], v[18:19] op_sel:[0,1] op_sel_hi:[1,1]
    v_cvt_pk_bf16_f32 v28, v40, v41
    v_cvt_pk_bf16_f32 v29, v42, v43
    v_pk_mul_f32 v[36:37], v[112:113], v[18:19] op_sel:[0,1] op_sel_hi:[1,1]
    v_pk_mul_f32 v[38:39], v[114:115], v[18:19] op_sel:[0,1] op_sel_hi:[1,1]
    v_cvt_pk_bf16_f32 v30, v36, v37
    v_cvt_pk_bf16_f32 v31, v38, v39
    buffer_store_dwordx4 v[28:31], v3, s[12:15], 0 offen offset:0 sc1
hgend_46:
noo_44:
    s_waitcnt vmcnt(0) lgkmcnt(0)
    s_cmp_ge_u32 s24, 4
    s_cbranch_scc1 nsig_47
    s_lshl_b32 s36, s25, 7
    s_add_u32 s36, s36, 45154304
    v_mov_b32 v16, 1
    v_mov_b32 v17, 0
    s_mov_b64 exec, 1
    buffer_atomic_add v16, v17, s[12:15], s36 offen offset:2048
    s_mov_b64 exec, -1
nsig_47:
    s_branch k2_entry
k1_exit:
    s_endpgm

.section .rodata,"a"
.p2align 6
.amdhsa_kernel k1_kernel
  .amdhsa_next_free_vgpr 256
  .amdhsa_next_free_sgpr 102
  .amdhsa_accum_offset 256
  .amdhsa_group_segment_fixed_size 0
  .amdhsa_kernarg_size 88
  .amdhsa_user_sgpr_count 2
  .amdhsa_user_sgpr_kernarg_segment_ptr 1
  .amdhsa_system_sgpr_workgroup_id_x 1
.end_amdhsa_kernel
.text

k2_entry:
    v_mbcnt_lo_u32_b32 v14, -1, 0
    v_mbcnt_hi_u32_b32 v14, -1, v14
    s_lshl_b32 s36, s24, 6
    v_add_u32 v0, s36, v14
    s_mul_i32 s27, s26, 10923
    s_lshr_b32 s27, s27, 16
    s_mul_i32 s37, s27, 6
    s_sub_u32 s37, s26, s37
    s_mul_i32 s28, s25, 6
    s_add_u32 s28, s28, s37
    s_mul_i32 s75, s37, 3
    s_and_b32 s36, s2, 7
    s_mul_i32 s36, s36, 6
    s_lshr_b32 s37, s2, 3
    s_add_u32 s36, s36, s37
    s_cmp_lt_u32 s2, 64
    s_cselect_b32 s27, 4, s27
    s_cselect_b32 s28, s36, s28
    s_cselect_b32 s75, 0, s75
    s_mul_i32 s25, s28, 21846
    s_lshr_b32 s25, s25, 16
    s_mul_i32 s37, s25, 3
    s_sub_u32 s26, s28, s37
    v_add_u32 v15, 0, v14
    v_mul_u32_u24 v16, 2731, v15
    v_lshrrev_b32 v16, 16, v16
    v_mul_u32_u24 v17, 24, v16
    v_sub_u32 v15, v15, v17
    v_and_b32 v18, 3, v15
    v_lshlrev_b32 v18, 4, v18
    v_lshrrev_b32 v17, 2, v15
    v_bfe_u32 v15, v16, 1, 1
    v_xor_b32 v17, v17, v15
    v_mul_u32_u24 v10, 1152, v16
    v_lshl_add_u32 v10, v17, 6, v10
    v_add_u32 v10, v10, v18
    v_add_u32 v15, 64, v14
    v_mul_u32_u24 v16, 2731, v15
    v_lshrrev_b32 v16, 16, v16
    v_mul_u32_u24 v17, 24, v16
    v_sub_u32 v15, v15, v17
    v_and_b32 v18, 3, v15
    v_lshlrev_b32 v18, 4, v18
    v_lshrrev_b32 v17, 2, v15
    v_bfe_u32 v15, v16, 1, 1
    v_xor_b32 v17, v17, v15
    v_mul_u32_u24 v11, 1152, v16
    v_lshl_add_u32 v11, v17, 6, v11
    v_add_u32 v11, v11, v18
    v_add_u32 v15, 128, v14
    v_mul_u32_u24 v16, 2731, v15
    v_lshrrev_b32 v16, 16, v16
    v_mul_u32_u24 v17, 24, v16
    v_sub_u32 v15, v15, v17
    v_and_b32 v18, 3, v15
    v_lshlrev_b32 v18, 4, v18
    v_lshrrev_b32 v17, 2, v15
    v_bfe_u32 v15, v16, 1, 1
    v_xor_b32 v17, v17, v15
    v_mul_u32_u24 v12, 1152, v16
    v_lshl_add_u32 v12, v17, 6, v12
    v_add_u32 v12, v12, v18
    v_lshlrev_b32 v13, 4, v14
    s_waitcnt lgkmcnt(0)
    s_mov_b32 s12, s68
    s_and_b32 s13, s69, 0xffff
    s_mov_b32 s14, 67108864
    s_mov_b32 s15, 0x00020000
    s_mov_b32 s20, s66
    s_and_b32 s21, s67, 0xffff
    s_mov_b32 s22, 256
    s_mov_b32 s23, 0x00020000
    s_sub_u32 s88, s2, 48
    s_cmp_lt_u32 s88, 16
    s_cbranch_scc1 k2_exit
    s_cmp_eq_u32 s27, 4
    s_cselect_b32 s36, s52, s60
    s_cselect_b32 s37, s53, s61
    s_mov_b32 s8, s36
    s_and_b32 s9, s37, 0xffff
    s_mov_b32 s10, 5308416
    s_mov_b32 s11, 0x00020000
    s_mov_b32 s16, s64
    s_and_b32 s17, s65, 0xffff
    s_mov_b32 s18, 2359296
    s_mov_b32 s19, 0x00020000
    s_cmp_eq_u32 s27, 4
    s_cselect_b32 s10, 663552, s10
    s_cselect_b32 s31, 9, 18
    s_cselect_b32 s33, 0, s27
    s_cmp_lt_u32 s24, 4
    s_cbranch_scc1 k2_compute
    s_sub_u32 s41, s24, 4
    s_mul_i32 s37, s33, 1152
    s_lshl_b32 s38, s41, 4
    s_add_u32 s37, s37, s38
    s_mul_i32 s29, s37, 1152
    s_mul_i32 s39, s26, 384
    s_add_u32 s29, s29, s39
    s_lshl_b32 s37, s25, 2
    s_add_u32 s37, s37, s41
    s_mul_i32 s37, s37, 331776
    s_mul_i32 s36, s27, 73728
    s_add_u32 s30, s37, s36
    s_lshl_b32 s36, s75, 12
    s_add_u32 s30, s30, s36
    s_mul_i32 s36, s75, 73728
    s_add_u32 s29, s29, s36
    s_add_u32 s75, s75, 3
    s_lshl_b32 s34, s41, 12
    s_add_u32 s34, s34, 98304
    s_mul_i32 s35, s41, 6144
    s_mov_b32 s32, 0
    s_mov_b32 s72, 0
    s_cmp_eq_u32 s27, 4
    s_cbranch_scc1 hpw_1002
    s_add_u32 s29, s29, 221184
    s_branch nhp_1001
hpw_1002:
k2_lpw:
    s_mov_b32 s70, s29
    s_add_u32 s36, s70, 9216
    s_mul_i32 s38, s72, 24576
    s_add_u32 s38, s38, s35
    s_add_u32 m0, s38, 0
    s_nop 0
    buffer_load_dwordx4 v10, s[8:11], s70 offen lds
    s_add_u32 m0, s38, 1024
    s_nop 0
    buffer_load_dwordx4 v11, s[8:11], s70 offen lds
    s_add_u32 m0, s38, 2048
    s_nop 0
    buffer_load_dwordx4 v12, s[8:11], s70 offen lds
    s_add_u32 m0, s38, 3072
    s_nop 0
    buffer_load_dwordx4 v10, s[8:11], s36 offen lds
    s_add_u32 m0, s38, 4096
    s_nop 0
    buffer_load_dwordx4 v11, s[8:11], s36 offen lds
    s_add_u32 m0, s38, 5120
    s_nop 0
    buffer_load_dwordx4 v12, s[8:11], s36 offen lds
    s_add_u32 s29, s29, 73728
    s_add_u32 s72, s72, 1
    s_cmp_lt_u32 s72, 3
    s_cbranch_scc1 k2_lpw
    s_lshr_b32 s37, s25, 1
    s_lshl_b32 s37, s37, 7
    s_add_u32 s37, s37, 45156352
    v_mov_b32 v17, 0
    s_mov_b64 exec, 1
    s_mov_b32 s88, 0
poll_1003:
    buffer_load_dword v16, v17, s[12:15], s37 offen offset:0 sc1
    s_waitcnt vmcnt(0)
    v_readfirstlane_b32 s38, v16
    s_nop 3
    s_cmp_ge_u32 s38, 32
    s_cbranch_scc1 pdone_1004
    s_sleep 8
    s_add_u32 s88, s88, 1
    s_cmp_lt_u32 s88, 0x40000
    s_cbranch_scc1 poll_1003
pdone_1004:
    s_mov_b64 exec, -1
nhp_1001:
    s_mov_b32 s72, 0
k2_lpb:
    s_mov_b32 s71, s30
    s_mul_i32 s37, s72, 16384
    s_add_u32 m0, s37, s34
    s_add_u32 s30, s30, 4096
    buffer_load_dwordx4 v13, s[12:15], s71 offen offset:0 sc1 lds
    buffer_load_dwordx4 v13, s[12:15], s71 offen offset:1024 sc1 lds
    buffer_load_dwordx4 v13, s[12:15], s71 offen offset:2048 sc1 lds
    buffer_load_dwordx4 v13, s[12:15], s71 offen offset:3072 sc1 lds
    s_add_u32 s72, s72, 1
    s_cmp_lt_u32 s72, 3
    s_cbranch_scc1 k2_lpb
    s_mov_b32 s32, 3
    s_waitcnt vmcnt(8)
    s_barrier
    s_waitcnt vmcnt(4)
k2_lloop:
    s_waitcnt vmcnt(10)
    s_barrier
    s_cmp_lg_u32 s32, 3
    s_cbranch_scc1 nh3_1005
    s_cmp_eq_u32 s27, 4
    s_cbranch_scc1 nh3_1005
    s_lshr_b32 s37, s25, 1
    s_lshl_b32 s37, s37, 7
    s_add_u32 s37, s37, 45154304
    v_mov_b32 v17, 0
    s_mov_b64 exec, 1
    s_mov_b32 s88, 0
poll_1006:
    buffer_load_dword v16, v17, s[12:15], s37 offen offset:0 sc1
    s_waitcnt vmcnt(0)
    v_readfirstlane_b32 s38, v16
    s_nop 3
    s_cmp_ge_u32 s38, 24
    s_cbranch_scc1 pdone_1007
    s_sleep 8
    s_add_u32 s88, s88, 1
    s_cmp_lt_u32 s88, 0x40000
    s_cbranch_scc1 poll_1006
pdone_1007:
    s_mov_b64 exec, -1
nh3_1005:
    s_cmp_lg_u32 s32, 17
    s_cbranch_scc1 nsw_1008
    s_lshr_b32 s37, s25, 1
    s_lshl_b32 s37, s37, 7
    s_add_u32 s37, s37, 45156352
    v_mov_b32 v17, 0
    s_mov_b64 exec, 1
    s_mov_b32 s88, 0
poll_1009:
    buffer_load_dword v16, v17, s[12:15], s37 offen offset:0 sc1
    s_waitcnt vmcnt(0)
    v_readfirstlane_b32 s38, v16
    s_nop 3
    s_cmp_ge_u32 s38, 32
    s_cbranch_scc1 pdone_1010
    s_sleep 8
    s_add_u32 s88, s88, 1
    s_cmp_lt_u32 s88, 0x40000
    s_cbranch_scc1 poll_1009
pdone_1010:
    s_mov_b64 exec, -1
nsw_1008:
    s_cmp_lg_u32 s75, 18
    s_cbranch_scc1 nwrap_1011
    s_sub_u32 s29, s29, 1327104
    s_sub_u32 s30, s30, 73728
nwrap_1011:
    s_add_u32 s75, s75, 1
    s_cmp_lt_u32 s32, s31
    s_cselect_b32 s70, s29, 2147418112
    s_cselect_b32 s71, s30, 2147418112
    s_mul_i32 s37, s72, 16384
    s_add_u32 m0, s37, s34
    s_add_u32 s30, s30, 4096
    buffer_load_dwordx4 v13, s[12:15], s71 offen offset:0 sc1 lds
    buffer_load_dwordx4 v13, s[12:15], s71 offen offset:1024 sc1 lds
    buffer_load_dwordx4 v13, s[12:15], s71 offen offset:2048 sc1 lds
    buffer_load_dwordx4 v13, s[12:15], s71 offen offset:3072 sc1 lds
    s_add_u32 s36, s70, 9216
    s_mul_i32 s38, s72, 24576
    s_add_u32 s38, s38, s35
    s_add_u32 m0, s38, 0
    s_nop 0
    buffer_load_dwordx4 v10, s[8:11], s70 offen lds
    s_add_u32 m0, s38, 1024
    s_nop 0
    buffer_load_dwordx4 v11, s[8:11], s70 offen lds
    s_add_u32 m0, s38, 2048
    s_nop 0
    buffer_load_dwordx4 v12, s[8:11], s70 offen lds
    s_add_u32 m0, s38, 3072
    s_nop 0
    buffer_load_dwordx4 v10, s[8:11], s36 offen lds
    s_add_u32 m0, s38, 4096
    s_nop 0
    buffer_load_dwordx4 v11, s[8:11], s36 offen lds
    s_add_u32 m0, s38, 5120
    s_nop 0
    buffer_load_dwordx4 v12, s[8:11], s36 offen lds
    s_add_u32 s29, s29, 73728
    s_add_u32 s32, s32, 1
    s_add_u32 s72, s72, 1
    s_and_b32 s72, s72, 3
    s_add_u32 s36, s31, 3
    s_cmp_lt_u32 s32, s36
    s_cbranch_scc1 k2_lloop
    s_branch k2_exit2
k2_compute:
    s_and_b32 s73, s24, 1
    s_lshr_b32 s74, s24, 1
    s_lshl_b32 s39, s25, 7
    s_lshl_b32 s37, s73, 6
    s_add_u32 s39, s39, s37
    v_and_b32 v20, 31, v14
    v_add_u32 v20, s39, v20
    v_lshlrev_b32 v15, 2, v20
    s_mov_b32 s39, 21233664
    v_mov_b32 v24, v15
    s_lshl_b32 s36, s73, 13
    s_add_u32 s36, s36, 98304
    v_add_u32 v7, s36, v13
    v_lshrrev_b32 v15, 5, v14
    v_lshlrev_b32 v16, 2, v15
    v_bfe_u32 v15, v14, 2, 2
    v_add_u32 v16, v16, v15
    v_mul_u32_u24 v16, 384, v16
    v_lshrrev_b32 v17, 1, v15
    v_bfe_u32 v15, v14, 4, 1
    v_lshl_add_u32 v16, v15, 5, v16
    v_and_b32 v15, 3, v14
    v_lshl_add_u32 v16, v15, 3, v16
    s_mul_i32 s36, s74, 3
    s_add_u32 s37, s36, 0
    v_xor_b32 v15, s37, v17
    v_lshl_add_u32 v1, v15, 6, v16
    v_add_u32 v4, 49152, v1
    s_add_u32 s37, s36, 1
    v_xor_b32 v15, s37, v17
    v_lshl_add_u32 v2, v15, 6, v16
    v_add_u32 v5, 49152, v2
    s_add_u32 s37, s36, 2
    v_xor_b32 v15, s37, v17
    v_lshl_add_u32 v3, v15, 6, v16
    v_add_u32 v6, 49152, v3
    v_mov_b32 v96, 0
    v_mov_b32 v97, 0
    v_mov_b32 v98, 0
    v_mov_b32 v99, 0
    v_mov_b32 v100, 0
    v_mov_b32 v101, 0
    v_mov_b32 v102, 0
    v_mov_b32 v103, 0
    v_mov_b32 v104, 0
    v_mov_b32 v105, 0
    v_mov_b32 v106, 0
    v_mov_b32 v107, 0
    v_mov_b32 v108, 0
    v_mov_b32 v109, 0
    v_mov_b32 v110, 0
    v_mov_b32 v111, 0
    v_mov_b32 v112, 0
    v_mov_b32 v113, 0
    v_mov_b32 v114, 0
    v_mov_b32 v115, 0
    v_mov_b32 v116, 0
    v_mov_b32 v117, 0
    v_mov_b32 v118, 0
    v_mov_b32 v119, 0
    v_mov_b32 v120, 0
    v_mov_b32 v121, 0
    v_mov_b32 v122, 0
    v_mov_b32 v123, 0
    v_mov_b32 v124, 0
    v_mov_b32 v125, 0
    v_mov_b32 v126, 0
    v_mov_b32 v127, 0
    v_mov_b32 v128, 0
    v_mov_b32 v129, 0
    v_mov_b32 v130, 0
    v_mov_b32 v131, 0
    v_mov_b32 v132, 0
    v_mov_b32 v133, 0
    v_mov_b32 v134, 0
    v_mov_b32 v135, 0
    v_mov_b32 v136, 0
    v_mov_b32 v137, 0
    v_mov_b32 v138, 0
    v_mov_b32 v139, 0
    v_mov_b32 v140, 0
    v_mov_b32 v141, 0
    v_mov_b32 v142, 0
    v_mov_b32 v143, 0
    v_mov_b32 v144, 0
    v_mov_b32 v145, 0
    v_mov_b32 v146, 0
    v_mov_b32 v147, 0
    v_mov_b32 v148, 0
    v_mov_b32 v149, 0
    v_mov_b32 v150, 0
    v_mov_b32 v151, 0
    v_mov_b32 v152, 0
    v_mov_b32 v153, 0
    v_mov_b32 v154, 0
    v_mov_b32 v155, 0
    v_mov_b32 v156, 0
    v_mov_b32 v157, 0
    v_mov_b32 v158, 0
    v_mov_b32 v159, 0
    v_mov_b32 v160, 0
    v_mov_b32 v161, 0
    v_mov_b32 v162, 0
    v_mov_b32 v163, 0
    v_mov_b32 v164, 0
    v_mov_b32 v165, 0
    v_mov_b32 v166, 0
    v_mov_b32 v167, 0
    v_mov_b32 v168, 0
    v_mov_b32 v169, 0
    v_mov_b32 v170, 0
    v_mov_b32 v171, 0
    v_mov_b32 v172, 0
    v_mov_b32 v173, 0
    v_mov_b32 v174, 0
    v_mov_b32 v175, 0
    v_mov_b32 v176, 0
    v_mov_b32 v177, 0
    v_mov_b32 v178, 0
    v_mov_b32 v179, 0
    v_mov_b32 v180, 0
    v_mov_b32 v181, 0
    v_mov_b32 v182, 0
    v_mov_b32 v183, 0
    v_mov_b32 v184, 0
    v_mov_b32 v185, 0
    v_mov_b32 v186, 0
    v_mov_b32 v187, 0
    v_mov_b32 v188, 0
    v_mov_b32 v189, 0
    v_mov_b32 v190, 0
    v_mov_b32 v191, 0
    s_waitcnt vmcnt(0)
    s_barrier
    s_sub_u32 s40, s31, 1
    ds_read_b64_tr_b16 v[48:49], v1 offset:0
    ds_read_b64_tr_b16 v[50:51], v1 offset:3072
    ds_read_b64_tr_b16 v[52:53], v2 offset:0
    ds_read_b128 v[32:35], v7 offset:0
    ds_read_b64_tr_b16 v[54:55], v2 offset:3072
    ds_read_b64_tr_b16 v[56:57], v3 offset:0
    ds_read_b128 v[36:39], v7 offset:4096
    ds_read_b64_tr_b16 v[58:59], v3 offset:3072
    ds_read_b64_tr_b16 v[60:61], v1 offset:6144
    ds_read_b64_tr_b16 v[62:63], v1 offset:9216
    s_mov_b32 s72, 0
k2_loop:
    s_waitcnt lgkmcnt(3)
    v_mfma_f32_32x32x16_bf16 v[96:111], v[48:51], v[32:35], v[96:111]
    ds_read_b64_tr_b16 v[64:65], v2 offset:6144
    ds_read_b128 v[40:43], v7 offset:1024
    v_mfma_f32_32x32x16_bf16 v[144:159], v[48:51], v[36:39], v[144:159]
    ds_read_b64_tr_b16 v[66:67], v2 offset:9216
    v_mfma_f32_32x32x16_bf16 v[112:127], v[52:55], v[32:35], v[112:127]
    ds_read_b64_tr_b16 v[68:69], v3 offset:6144
    ds_read_b128 v[44:47], v7 offset:5120
    v_mfma_f32_32x32x16_bf16 v[160:175], v[52:55], v[36:39], v[160:175]
    ds_read_b64_tr_b16 v[70:71], v3 offset:9216
    s_waitcnt lgkmcnt(8)
    v_mfma_f32_32x32x16_bf16 v[128:143], v[56:59], v[32:35], v[128:143]
    ds_read_b64_tr_b16 v[48:49], v1 offset:12288
    v_mfma_f32_32x32x16_bf16 v[176:191], v[56:59], v[36:39], v[176:191]
    ds_read_b64_tr_b16 v[50:51], v1 offset:15360
    s_waitcnt lgkmcnt(3)
    v_mfma_f32_32x32x16_bf16 v[96:111], v[60:63], v[40:43], v[96:111]
    ds_read_b64_tr_b16 v[52:53], v2 offset:12288
    ds_read_b128 v[32:35], v7 offset:2048
    v_mfma_f32_32x32x16_bf16 v[144:159], v[60:63], v[44:47], v[144:159]
    ds_read_b64_tr_b16 v[54:55], v2 offset:15360
    v_mfma_f32_32x32x16_bf16 v[112:127], v[64:67], v[40:43], v[112:127]
    ds_read_b64_tr_b16 v[56:57], v3 offset:12288
    ds_read_b128 v[36:39], v7 offset:6144
    v_mfma_f32_32x32x16_bf16 v[160:175], v[64:67], v[44:47], v[160:175]
    ds_read_b64_tr_b16 v[58:59], v3 offset:15360
    s_waitcnt lgkmcnt(8)
    v_mfma_f32_32x32x16_bf16 v[128:143], v[68:71], v[40:43], v[128:143]
    ds_read_b64_tr_b16 v[60:61], v1 offset:18432
    v_mfma_f32_32x32x16_bf16 v[176:191], v[68:71], v[44:47], v[176:191]
    ds_read_b64_tr_b16 v[62:63], v1 offset:21504
    s_barrier
    s_waitcnt lgkmcnt(3)
    v_mfma_f32_32x32x16_bf16 v[96:111], v[48:51], v[32:35], v[96:111]
    ds_read_b64_tr_b16 v[64:65], v2 offset:18432
    ds_read_b128 v[40:43], v7 offset:3072
    v_mfma_f32_32x32x16_bf16 v[144:159], v[48:51], v[36:39], v[144:159]
    ds_read_b64_tr_b16 v[66:67], v2 offset:21504
    v_mfma_f32_32x32x16_bf16 v[112:127], v[52:55], v[32:35], v[112:127]
    ds_read_b64_tr_b16 v[68:69], v3 offset:18432
    ds_read_b128 v[44:47], v7 offset:7168
    v_mfma_f32_32x32x16_bf16 v[160:175], v[52:55], v[36:39], v[160:175]
    ds_read_b64_tr_b16 v[70:71], v3 offset:21504
    s_waitcnt lgkmcnt(8)
    v_mfma_f32_32x32x16_bf16 v[128:143], v[56:59], v[32:35], v[128:143]
    ds_read_b64_tr_b16 v[48:49], v1 offset:24576
    v_mfma_f32_32x32x16_bf16 v[176:191], v[56:59], v[36:39], v[176:191]
    ds_read_b64_tr_b16 v[50:51], v1 offset:27648
    s_waitcnt lgkmcnt(3)
    v_mfma_f32_32x32x16_bf16 v[96:111], v[60:63], v[40:43], v[96:111]
    ds_read_b64_tr_b16 v[52:53], v2 offset:24576
    ds_read_b128 v[32:35], v7 offset:16384
    v_mfma_f32_32x32x16_bf16 v[144:159], v[60:63], v[44:47], v[144:159]
    ds_read_b64_tr_b16 v[54:55], v2 offset:27648
    v_mfma_f32_32x32x16_bf16 v[112:127], v[64:67], v[40:43], v[112:127]
    ds_read_b64_tr_b16 v[56:57], v3 offset:24576
    ds_read_b128 v[36:39], v7 offset:20480
    v_mfma_f32_32x32x16_bf16 v[160:175], v[64:67], v[44:47], v[160:175]
    ds_read_b64_tr_b16 v[58:59], v3 offset:27648
    s_waitcnt lgkmcnt(8)
    v_mfma_f32_32x32x16_bf16 v[128:143], v[68:71], v[40:43], v[128:143]
    ds_read_b64_tr_b16 v[60:61], v1 offset:30720
    v_mfma_f32_32x32x16_bf16 v[176:191], v[68:71], v[44:47], v[176:191]
    ds_read_b64_tr_b16 v[62:63], v1 offset:33792
    s_add_u32 s72, s72, 1
    s_cmp_lg_u32 s72, s40
    s_cbranch_scc1 ngl_1012
    s_mov_b32 s39, 21233664
    buffer_load_dword v22, v24, s[12:15], s39 offen sc1
    buffer_load_dword v23, v24, s[12:15], s39 offen offset:128 sc1
ngl_1012:
    s_cmp_ge_u32 s72, s31
    s_cbranch_scc1 k2_done
    s_waitcnt lgkmcnt(3)
    v_mfma_f32_32x32x16_bf16 v[96:111], v[48:51], v[32:35], v[96:111]
    ds_read_b64_tr_b16 v[64:65], v2 offset:30720
    ds_read_b128 v[40:43], v7 offset:17408
    v_mfma_f32_32x32x16_bf16 v[144:159], v[48:51], v[36:39], v[144:159]
    ds_read_b64_tr_b16 v[66:67], v2 offset:33792
    v_mfma_f32_32x32x16_bf16 v[112:127], v[52:55], v[32:35], v[112:127]
    ds_read_b64_tr_b16 v[68:69], v3 offset:30720
    ds_read_b128 v[44:47], v7 offset:21504
    v_mfma_f32_32x32x16_bf16 v[160:175], v[52:55], v[36:39], v[160:175]
    ds_read_b64_tr_b16 v[70:71], v3 offset:33792
    s_waitcnt lgkmcnt(8)
    v_mfma_f32_32x32x16_bf16 v[128:143], v[56:59], v[32:35], v[128:143]
    ds_read_b64_tr_b16 v[48:49], v1 offset:36864
    v_mfma_f32_32x32x16_bf16 v[176:191], v[56:59], v[36:39], v[176:191]
    ds_read_b64_tr_b16 v[50:51], v1 offset:39936
    s_waitcnt lgkmcnt(3)
    v_mfma_f32_32x32x16_bf16 v[96:111], v[60:63], v[40:43], v[96:111]
    ds_read_b64_tr_b16 v[52:53], v2 offset:36864
    ds_read_b128 v[32:35], v7 offset:18432
    v_mfma_f32_32x32x16_bf16 v[144:159], v[60:63], v[44:47], v[144:159]
    ds_read_b64_tr_b16 v[54:55], v2 offset:39936
    v_mfma_f32_32x32x16_bf16 v[112:127], v[64:67], v[40:43], v[112:127]
    ds_read_b64_tr_b16 v[56:57], v3 offset:36864
    ds_read_b128 v[36:39], v7 offset:22528
    v_mfma_f32_32x32x16_bf16 v[160:175], v[64:67], v[44:47], v[160:175]
    ds_read_b64_tr_b16 v[58:59], v3 offset:39936
    s_waitcnt lgkmcnt(8)
    v_mfma_f32_32x32x16_bf16 v[128:143], v[68:71], v[40:43], v[128:143]
    ds_read_b64_tr_b16 v[60:61], v1 offset:43008
    v_mfma_f32_32x32x16_bf16 v[176:191], v[68:71], v[44:47], v[176:191]
    ds_read_b64_tr_b16 v[62:63], v1 offset:46080
    s_barrier
    s_waitcnt lgkmcnt(3)
    v_mfma_f32_32x32x16_bf16 v[96:111], v[48:51], v[32:35], v[96:111]
    ds_read_b64_tr_b16 v[64:65], v2 offset:43008
    ds_read_b128 v[40:43], v7 offset:19456
    v_mfma_f32_32x32x16_bf16 v[144:159], v[48:51], v[36:39], v[144:159]
    ds_read_b64_tr_b16 v[66:67], v2 offset:46080
    v_mfma_f32_32x32x16_bf16 v[112:127], v[52:55], v[32:35], v[112:127]
    ds_read_b64_tr_b16 v[68:69], v3 offset:43008
    ds_read_b128 v[44:47], v7 offset:23552
    v_mfma_f32_32x32x16_bf16 v[160:175], v[52:55], v[36:39], v[160:175]
    ds_read_b64_tr_b16 v[70:71], v3 offset:46080
    s_waitcnt lgkmcnt(8)
    v_mfma_f32_32x32x16_bf16 v[128:143], v[56:59], v[32:35], v[128:143]
    ds_read_b64_tr_b16 v[48:49], v4 offset:0
    v_mfma_f32_32x32x16_bf16 v[176:191], v[56:59], v[36:39], v[176:191]
    ds_read_b64_tr_b16 v[50:51], v4 offset:3072
    s_waitcnt lgkmcnt(3)
    v_mfma_f32_32x32x16_bf16 v[96:111], v[60:63], v[40:43], v[96:111]
    ds_read_b64_tr_b16 v[52:53], v5 offset:0
    ds_read_b128 v[32:35], v7 offset:32768
    v_mfma_f32_32x32x16_bf16 v[144:159], v[60:63], v[44:47], v[144:159]
    ds_read_b64_tr_b16 v[54:55], v5 offset:3072
    v_mfma_f32_32x32x16_bf16 v[112:127], v[64:67], v[40:43], v[112:127]
    ds_read_b64_tr_b16 v[56:57], v6 offset:0
    ds_read_b128 v[36:39], v7 offset:36864
    v_mfma_f32_32x32x16_bf16 v[160:175], v[64:67], v[44:47], v[160:175]
    ds_read_b64_tr_b16 v[58:59], v6 offset:3072
    s_waitcnt lgkmcnt(8)
    v_mfma_f32_32x32x16_bf16 v[128:143], v[68:71], v[40:43], v[128:143]
    ds_read_b64_tr_b16 v[60:61], v4 offset:6144
    v_mfma_f32_32x32x16_bf16 v[176:191], v[68:71], v[44:47], v[176:191]
    ds_read_b64_tr_b16 v[62:63], v4 offset:9216
    s_add_u32 s72, s72, 1
    s_cmp_ge_u32 s72, s31
    s_cbranch_scc1 k2_done
    s_waitcnt lgkmcnt(3)
    v_mfma_f32_32x32x16_bf16 v[96:111], v[48:51], v[32:35], v[96:111]
    ds_read_b64_tr_b16 v[64:65], v5 offset:6144
    ds_read_b128 v[40:43], v7 offset:33792
    v_mfma_f32_32x32x16_bf16 v[144:159], v[48:51], v[36:39], v[144:159]
    ds_read_b64_tr_b16 v[66:67], v5 offset:9216
    v_mfma_f32_32x32x16_bf16 v[112:127], v[52:55], v[32:35], v[112:127]
    ds_read_b64_tr_b16 v[68:69], v6 offset:6144
    ds_read_b128 v[44:47], v7 offset:37888
    v_mfma_f32_32x32x16_bf16 v[160:175], v[52:55], v[36:39], v[160:175]
    ds_read_b64_tr_b16 v[70:71], v6 offset:9216
    s_waitcnt lgkmcnt(8)
    v_mfma_f32_32x32x16_bf16 v[128:143], v[56:59], v[32:35], v[128:143]
    ds_read_b64_tr_b16 v[48:49], v4 offset:12288
    v_mfma_f32_32x32x16_bf16 v[176:191], v[56:59], v[36:39], v[176:191]
    ds_read_b64_tr_b16 v[50:51], v4 offset:15360
    s_waitcnt lgkmcnt(3)
    v_mfma_f32_32x32x16_bf16 v[96:111], v[60:63], v[40:43], v[96:111]
    ds_read_b64_tr_b16 v[52:53], v5 offset:12288
    ds_read_b128 v[32:35], v7 offset:34816
    v_mfma_f32_32x32x16_bf16 v[144:159], v[60:63], v[44:47], v[144:159]
    ds_read_b64_tr_b16 v[54:55], v5 offset:15360
    v_mfma_f32_32x32x16_bf16 v[112:127], v[64:67], v[40:43], v[112:127]
    ds_read_b64_tr_b16 v[56:57], v6 offset:12288
    ds_read_b128 v[36:39], v7 offset:38912
    v_mfma_f32_32x32x16_bf16 v[160:175], v[64:67], v[44:47], v[160:175]
    ds_read_b64_tr_b16 v[58:59], v6 offset:15360
    s_waitcnt lgkmcnt(8)
    v_mfma_f32_32x32x16_bf16 v[128:143], v[68:71], v[40:43], v[128:143]
    ds_read_b64_tr_b16 v[60:61], v4 offset:18432
    v_mfma_f32_32x32x16_bf16 v[176:191], v[68:71], v[44:47], v[176:191]
    ds_read_b64_tr_b16 v[62:63], v4 offset:21504
    s_barrier
    s_waitcnt lgkmcnt(3)
    v_mfma_f32_32x32x16_bf16 v[96:111], v[48:51], v[32:35], v[96:111]
    ds_read_b64_tr_b16 v[64:65], v5 offset:18432
    ds_read_b128 v[40:43], v7 offset:35840
    v_mfma_f32_32x32x16_bf16 v[144:159], v[48:51], v[36:39], v[144:159]
    ds_read_b64_tr_b16 v[66:67], v5 offset:21504
    v_mfma_f32_32x32x16_bf16 v[112:127], v[52:55], v[32:35], v[112:127]
    ds_read_b64_tr_b16 v[68:69], v6 offset:18432
    ds_read_b128 v[44:47], v7 offset:39936
    v_mfma_f32_32x32x16_bf16 v[160:175], v[52:55], v[36:39], v[160:175]
    ds_read_b64_tr_b16 v[70:71], v6 offset:21504
    s_waitcnt lgkmcnt(8)
    v_mfma_f32_32x32x16_bf16 v[128:143], v[56:59], v[32:35], v[128:143]
    ds_read_b64_tr_b16 v[48:49], v4 offset:24576
    v_mfma_f32_32x32x16_bf16 v[176:191], v[56:59], v[36:39], v[176:191]
    ds_read_b64_tr_b16 v[50:51], v4 offset:27648
    s_waitcnt lgkmcnt(3)
    v_mfma_f32_32x32x16_bf16 v[96:111], v[60:63], v[40:43], v[96:111]
    ds_read_b64_tr_b16 v[52:53], v5 offset:24576
    ds_read_b128 v[32:35], v7 offset:49152
    v_mfma_f32_32x32x16_bf16 v[144:159], v[60:63], v[44:47], v[144:159]
    ds_read_b64_tr_b16 v[54:55], v5 offset:27648
    v_mfma_f32_32x32x16_bf16 v[112:127], v[64:67], v[40:43], v[112:127]
    ds_read_b64_tr_b16 v[56:57], v6 offset:24576
    ds_read_b128 v[36:39], v7 offset:53248
    v_mfma_f32_32x32x16_bf16 v[160:175], v[64:67], v[44:47], v[160:175]
    ds_read_b64_tr_b16 v[58:59], v6 offset:27648
    s_waitcnt lgkmcnt(8)
    v_mfma_f32_32x32x16_bf16 v[128:143], v[68:71], v[40:43], v[128:143]
    ds_read_b64_tr_b16 v[60:61], v4 offset:30720
    v_mfma_f32_32x32x16_bf16 v[176:191], v[68:71], v[44:47], v[176:191]
    ds_read_b64_tr_b16 v[62:63], v4 offset:33792
    s_add_u32 s72, s72, 1
    s_waitcnt lgkmcnt(3)
    v_mfma_f32_32x32x16_bf16 v[96:111], v[48:51], v[32:35], v[96:111]
    ds_read_b64_tr_b16 v[64:65], v5 offset:30720
    ds_read_b128 v[40:43], v7 offset:50176
    v_mfma_f32_32x32x16_bf16 v[144:159], v[48:51], v[36:39], v[144:159]
    ds_read_b64_tr_b16 v[66:67], v5 offset:33792
    v_mfma_f32_32x32x16_bf16 v[112:127], v[52:55], v[32:35], v[112:127]
    ds_read_b64_tr_b16 v[68:69], v6 offset:30720
    ds_read_b128 v[44:47], v7 offset:54272
    v_mfma_f32_32x32x16_bf16 v[160:175], v[52:55], v[36:39], v[160:175]
    ds_read_b64_tr_b16 v[70:71], v6 offset:33792
    s_waitcnt lgkmcnt(8)
    v_mfma_f32_32x32x16_bf16 v[128:143], v[56:59], v[32:35], v[128:143]
    ds_read_b64_tr_b16 v[48:49], v4 offset:36864
    v_mfma_f32_32x32x16_bf16 v[176:191], v[56:59], v[36:39], v[176:191]
    ds_read_b64_tr_b16 v[50:51], v4 offset:39936
    s_waitcnt lgkmcnt(3)
    v_mfma_f32_32x32x16_bf16 v[96:111], v[60:63], v[40:43], v[96:111]
    ds_read_b64_tr_b16 v[52:53], v5 offset:36864
    ds_read_b128 v[32:35], v7 offset:51200
    v_mfma_f32_32x32x16_bf16 v[144:159], v[60:63], v[44:47], v[144:159]
    ds_read_b64_tr_b16 v[54:55], v5 offset:39936
    v_mfma_f32_32x32x16_bf16 v[112:127], v[64:67], v[40:43], v[112:127]
    ds_read_b64_tr_b16 v[56:57], v6 offset:36864
    ds_read_b128 v[36:39], v7 offset:55296
    v_mfma_f32_32x32x16_bf16 v[160:175], v[64:67], v[44:47], v[160:175]
    ds_read_b64_tr_b16 v[58:59], v6 offset:39936
    s_waitcnt lgkmcnt(8)
    v_mfma_f32_32x32x16_bf16 v[128:143], v[68:71], v[40:43], v[128:143]
    ds_read_b64_tr_b16 v[60:61], v4 offset:43008
    v_mfma_f32_32x32x16_bf16 v[176:191], v[68:71], v[44:47], v[176:191]
    ds_read_b64_tr_b16 v[62:63], v4 offset:46080
    s_barrier
    s_waitcnt lgkmcnt(3)
    v_mfma_f32_32x32x16_bf16 v[96:111], v[48:51], v[32:35], v[96:111]
    ds_read_b64_tr_b16 v[64:65], v5 offset:43008
    ds_read_b128 v[40:43], v7 offset:52224
    v_mfma_f32_32x32x16_bf16 v[144:159], v[48:51], v[36:39], v[144:159]
    ds_read_b64_tr_b16 v[66:67], v5 offset:46080
    v_mfma_f32_32x32x16_bf16 v[112:127], v[52:55], v[32:35], v[112:127]
    ds_read_b64_tr_b16 v[68:69], v6 offset:43008
    ds_read_b128 v[44:47], v7 offset:56320
    v_mfma_f32_32x32x16_bf16 v[160:175], v[52:55], v[36:39], v[160:175]
    ds_read_b64_tr_b16 v[70:71], v6 offset:46080
    s_waitcnt lgkmcnt(8)
    v_mfma_f32_32x32x16_bf16 v[128:143], v[56:59], v[32:35], v[128:143]
    ds_read_b64_tr_b16 v[48:49], v1 offset:0
    v_mfma_f32_32x32x16_bf16 v[176:191], v[56:59], v[36:39], v[176:191]
    ds_read_b64_tr_b16 v[50:51], v1 offset:3072
    s_waitcnt lgkmcnt(3)
    v_mfma_f32_32x32x16_bf16 v[96:111], v[60:63], v[40:43], v[96:111]
    ds_read_b64_tr_b16 v[52:53], v2 offset:0
    ds_read_b128 v[32:35], v7 offset:0
    v_mfma_f32_32x32x16_bf16 v[144:159], v[60:63], v[44:47], v[144:159]
    ds_read_b64_tr_b16 v[54:55], v2 offset:3072
    v_mfma_f32_32x32x16_bf16 v[112:127], v[64:67], v[40:43], v[112:127]
    ds_read_b64_tr_b16 v[56:57], v3 offset:0
    ds_read_b128 v[36:39], v7 offset:4096
    v_mfma_f32_32x32x16_bf16 v[160:175], v[64:67], v[44:47], v[160:175]
    ds_read_b64_tr_b16 v[58:59], v3 offset:3072
    s_waitcnt lgkmcnt(8)
    v_mfma_f32_32x32x16_bf16 v[128:143], v[68:71], v[40:43], v[128:143]
    ds_read_b64_tr_b16 v[60:61], v1 offset:6144
    v_mfma_f32_32x32x16_bf16 v[176:191], v[68:71], v[44:47], v[176:191]
    ds_read_b64_tr_b16 v[62:63], v1 offset:9216
    s_add_u32 s72, s72, 1
    s_cmp_lg_u32 s72, s40
    s_cbranch_scc1 ngl_1013
    s_mov_b32 s39, 21233664
    buffer_load_dword v22, v24, s[12:15], s39 offen sc1
    buffer_load_dword v23, v24, s[12:15], s39 offen offset:128 sc1
ngl_1013:
    s_branch k2_loop
k2_done:
    s_waitcnt lgkmcnt(0)
    s_nop 15
    s_mov_b32 s33, s31
    s_cmp_lg_u32 s72, s33
    s_cbranch_scc1 nsc_1014
    s_waitcnt vmcnt(0)
    s_cmp_eq_u32 s27, 4
    s_cbranch_scc1 hlp_1015
    v_sub_f32 v22, 1.0, v22
    v_sub_f32 v23, 1.0, v23
hlp_1015:
    s_nop 15
    v_mul_f32 v96, v22, v96
    v_mul_f32 v97, v22, v97
    v_mul_f32 v98, v22, v98
    v_mul_f32 v99, v22, v99
    v_mul_f32 v100, v22, v100
    v_mul_f32 v101, v22, v101
    v_mul_f32 v102, v22, v102
    v_mul_f32 v103, v22, v103
    v_mul_f32 v104, v22, v104
    v_mul_f32 v105, v22, v105
    v_mul_f32 v106, v22, v106
    v_mul_f32 v107, v22, v107
    v_mul_f32 v108, v22, v108
    v_mul_f32 v109, v22, v109
    v_mul_f32 v110, v22, v110
    v_mul_f32 v111, v22, v111
    v_mul_f32 v112, v22, v112
    v_mul_f32 v113, v22, v113
    v_mul_f32 v114, v22, v114
    v_mul_f32 v115, v22, v115
    v_mul_f32 v116, v22, v116
    v_mul_f32 v117, v22, v117
    v_mul_f32 v118, v22, v118
    v_mul_f32 v119, v22, v119
    v_mul_f32 v120, v22, v120
    v_mul_f32 v121, v22, v121
    v_mul_f32 v122, v22, v122
    v_mul_f32 v123, v22, v123
    v_mul_f32 v124, v22, v124
    v_mul_f32 v125, v22, v125
    v_mul_f32 v126, v22, v126
    v_mul_f32 v127, v22, v127
    v_mul_f32 v128, v22, v128
    v_mul_f32 v129, v22, v129
    v_mul_f32 v130, v22, v130
    v_mul_f32 v131, v22, v131
    v_mul_f32 v132, v22, v132
    v_mul_f32 v133, v22, v133
    v_mul_f32 v134, v22, v134
    v_mul_f32 v135, v22, v135
    v_mul_f32 v136, v22, v136
    v_mul_f32 v137, v22, v137
    v_mul_f32 v138, v22, v138
    v_mul_f32 v139, v22, v139
    v_mul_f32 v140, v22, v140
    v_mul_f32 v141, v22, v141
    v_mul_f32 v142, v22, v142
    v_mul_f32 v143, v22, v143
    v_mul_f32 v144, v23, v144
    v_mul_f32 v145, v23, v145
    v_mul_f32 v146, v23, v146
    v_mul_f32 v147, v23, v147
    v_mul_f32 v148, v23, v148
    v_mul_f32 v149, v23, v149
    v_mul_f32 v150, v23, v150
    v_mul_f32 v151, v23, v151
    v_mul_f32 v152, v23, v152
    v_mul_f32 v153, v23, v153
    v_mul_f32 v154, v23, v154
    v_mul_f32 v155, v23, v155
    v_mul_f32 v156, v23, v156
    v_mul_f32 v157, v23, v157
    v_mul_f32 v158, v23, v158
    v_mul_f32 v159, v23, v159
    v_mul_f32 v160, v23, v160
    v_mul_f32 v161, v23, v161
    v_mul_f32 v162, v23, v162
    v_mul_f32 v163, v23, v163
    v_mul_f32 v164, v23, v164
    v_mul_f32 v165, v23, v165
    v_mul_f32 v166, v23, v166
    v_mul_f32 v167, v23, v167
    v_mul_f32 v168, v23, v168
    v_mul_f32 v169, v23, v169
    v_mul_f32 v170, v23, v170
    v_mul_f32 v171, v23, v171
    v_mul_f32 v172, v23, v172
    v_mul_f32 v173, v23, v173
    v_mul_f32 v174, v23, v174
    v_mul_f32 v175, v23, v175
    v_mul_f32 v176, v23, v176
    v_mul_f32 v177, v23, v177
    v_mul_f32 v178, v23, v178
    v_mul_f32 v179, v23, v179
    v_mul_f32 v180, v23, v180
    v_mul_f32 v181, v23, v181
    v_mul_f32 v182, v23, v182
    v_mul_f32 v183, v23, v183
    v_mul_f32 v184, v23, v184
    v_mul_f32 v185, v23, v185
    v_mul_f32 v186, v23, v186
    v_mul_f32 v187, v23, v187
    v_mul_f32 v188, v23, v188
    v_mul_f32 v189, v23, v189
    v_mul_f32 v190, v23, v190
    v_mul_f32 v191, v23, v191
nsc_1014:
    s_mul_i32 s36, s28, 245760
    s_lshl_b32 s41, s73, 2
    s_add_u32 s41, s41, s74
    s_lshl_b32 s37, s41, 11
    s_add_u32 s36, s36, s37
    s_add_u32 s36, s36, 21602304
    s_mul_i32 s37, s27, 16384
    s_add_u32 s37, s37, s36
    v_add_u32 v12, 4096, v13
    s_cmp_eq_u32 s27, 0
    s_cselect_b32 s38, 2147418112, s37
    v_cvt_pk_bf16_f32 v32, v96, v97
    v_cvt_pk_bf16_f32 v33, v98, v99
    v_cvt_pk_bf16_f32 v34, v100, v101
    v_cvt_pk_bf16_f32 v35, v102, v103
    v_cvt_pk_bf16_f32 v36, v104, v105
    v_cvt_pk_bf16_f32 v37, v106, v107
    v_cvt_pk_bf16_f32 v38, v108, v109
    v_cvt_pk_bf16_f32 v39, v110, v111
    buffer_store_dwordx4 v[32:35], v13, s[12:15], s38 offen sc1
    buffer_store_dwordx4 v[36:39], v13, s[12:15], s38 offen offset:1024 sc1
    v_cvt_pk_bf16_f32 v40, v144, v145
    v_cvt_pk_bf16_f32 v41, v146, v147
    v_cvt_pk_bf16_f32 v42, v148, v149
    v_cvt_pk_bf16_f32 v43, v150, v151
    v_cvt_pk_bf16_f32 v44, v152, v153
    v_cvt_pk_bf16_f32 v45, v154, v155
    v_cvt_pk_bf16_f32 v46, v156, v157
    v_cvt_pk_bf16_f32 v47, v158, v159
    buffer_store_dwordx4 v[40:43], v12, s[12:15], s38 offen sc1
    buffer_store_dwordx4 v[44:47], v12, s[12:15], s38 offen offset:1024 sc1
    s_add_u32 s37, s37, 81920
    s_cmp_eq_u32 s27, 1
    s_cselect_b32 s38, 2147418112, s37
    v_cvt_pk_bf16_f32 v48, v112, v113
    v_cvt_pk_bf16_f32 v49, v114, v115
    v_cvt_pk_bf16_f32 v50, v116, v117
    v_cvt_pk_bf16_f32 v51, v118, v119
    v_cvt_pk_bf16_f32 v52, v120, v121
    v_cvt_pk_bf16_f32 v53, v122, v123
    v_cvt_pk_bf16_f32 v54, v124, v125
    v_cvt_pk_bf16_f32 v55, v126, v127
    buffer_store_dwordx4 v[48:51], v13, s[12:15], s38 offen sc1
    buffer_store_dwordx4 v[52:55], v13, s[12:15], s38 offen offset:1024 sc1
    v_cvt_pk_bf16_f32 v56, v160, v161
    v_cvt_pk_bf16_f32 v57, v162, v163
    v_cvt_pk_bf16_f32 v58, v164, v165
    v_cvt_pk_bf16_f32 v59, v166, v167
    v_cvt_pk_bf16_f32 v60, v168, v169
    v_cvt_pk_bf16_f32 v61, v170, v171
    v_cvt_pk_bf16_f32 v62, v172, v173
    v_cvt_pk_bf16_f32 v63, v174, v175
    buffer_store_dwordx4 v[56:59], v12, s[12:15], s38 offen sc1
    buffer_store_dwordx4 v[60:63], v12, s[12:15], s38 offen offset:1024 sc1
    s_add_u32 s37, s37, 81920
    s_cmp_eq_u32 s27, 2
    s_cselect_b32 s38, 2147418112, s37
    v_cvt_pk_bf16_f32 v64, v128, v129
    v_cvt_pk_bf16_f32 v65, v130, v131
    v_cvt_pk_bf16_f32 v66, v132, v133
    v_cvt_pk_bf16_f32 v67, v134, v135
    v_cvt_pk_bf16_f32 v68, v136, v137
    v_cvt_pk_bf16_f32 v69, v138, v139
    v_cvt_pk_bf16_f32 v70, v140, v141
    v_cvt_pk_bf16_f32 v71, v142, v143
    buffer_store_dwordx4 v[64:67], v13, s[12:15], s38 offen sc1
    buffer_store_dwordx4 v[68:71], v13, s[12:15], s38 offen offset:1024 sc1
    v_cvt_pk_bf16_f32 v72, v176, v177
    v_cvt_pk_bf16_f32 v73, v178, v179
    v_cvt_pk_bf16_f32 v74, v180, v181
    v_cvt_pk_bf16_f32 v75, v182, v183
    v_cvt_pk_bf16_f32 v76, v184, v185
    v_cvt_pk_bf16_f32 v77, v186, v187
    v_cvt_pk_bf16_f32 v78, v188, v189
    v_cvt_pk_bf16_f32 v79, v190, v191
    buffer_store_dwordx4 v[72:75], v12, s[12:15], s38 offen sc1
    buffer_store_dwordx4 v[76:79], v12, s[12:15], s38 offen offset:1024 sc1
    s_mul_i32 s37, s28, 768
    s_lshl_b32 s38, s41, 5
    s_add_u32 s37, s37, s38
    s_add_u32 s40, s37, 45088768
    s_lshl_b32 s38, s27, 2
    s_add_u32 s37, s40, s38
    v_lshlrev_b32 v16, 8, v14
    v_mov_b32 v17, 1
    s_cmp_lg_u32 s27, 1
    s_cbranch_scc1 own_1016
    v_mov_b32 v96, v112
    v_mov_b32 v97, v113
    v_mov_b32 v98, v114
    v_mov_b32 v99, v115
    v_mov_b32 v100, v116
    v_mov_b32 v101, v117
    v_mov_b32 v102, v118
    v_mov_b32 v103, v119
    v_mov_b32 v104, v120
    v_mov_b32 v105, v121
    v_mov_b32 v106, v122
    v_mov_b32 v107, v123
    v_mov_b32 v108, v124
    v_mov_b32 v109, v125
    v_mov_b32 v110, v126
    v_mov_b32 v111, v127
    v_mov_b32 v144, v160
    v_mov_b32 v145, v161
    v_mov_b32 v146, v162
    v_mov_b32 v147, v163
    v_mov_b32 v148, v164
    v_mov_b32 v149, v165
    v_mov_b32 v150, v166
    v_mov_b32 v151, v167
    v_mov_b32 v152, v168
    v_mov_b32 v153, v169
    v_mov_b32 v154, v170
    v_mov_b32 v155, v171
    v_mov_b32 v156, v172
    v_mov_b32 v157, v173
    v_mov_b32 v158, v174
    v_mov_b32 v159, v175
own_1016:
    s_cmp_lg_u32 s27, 2
    s_cbranch_scc1 own_1017
    v_mov_b32 v96, v128
    v_mov_b32 v97, v129
    v_mov_b32 v98, v130
    v_mov_b32 v99, v131
    v_mov_b32 v100, v132
    v_mov_b32 v101, v133
    v_mov_b32 v102, v134
    v_mov_b32 v103, v135
    v_mov_b32 v104, v136
    v_mov_b32 v105, v137
    v_mov_b32 v106, v138
    v_mov_b32 v107, v139
    v_mov_b32 v108, v140
    v_mov_b32 v109, v141
    v_mov_b32 v110, v142
    v_mov_b32 v111, v143
    v_mov_b32 v144, v176
    v_mov_b32 v145, v177
    v_mov_b32 v146, v178
    v_mov_b32 v147, v179
    v_mov_b32 v148, v180
    v_mov_b32 v149, v181
    v_mov_b32 v150, v182
    v_mov_b32 v151, v183
    v_mov_b32 v152, v184
    v_mov_b32 v153, v185
    v_mov_b32 v154, v186
    v_mov_b32 v155, v187
    v_mov_b32 v156, v188
    v_mov_b32 v157, v189
    v_mov_b32 v158, v190
    v_mov_b32 v159, v191
own_1017:
    s_waitcnt vmcnt(0)
    s_mov_b64 exec, 7
    buffer_store_dword v17, v16, s[12:15], s37 offen sc1
    s_mov_b64 exec, -1
    s_cmp_ge_u32 s27, 3
    s_cbranch_scc1 k2_exit2
    s_mul_i32 s37, s27, 81920
    s_add_u32 s37, s37, s36
    s_cmp_eq_u32 s27, 0
    s_cselect_b32 s82, 2147418112, s37
    s_add_u32 s37, s37, 16384
    s_cmp_eq_u32 s27, 1
    s_cselect_b32 s83, 2147418112, s37
    s_add_u32 s37, s37, 16384
    s_cmp_eq_u32 s27, 2
    s_cselect_b32 s84, 2147418112, s37
    s_add_u32 s37, s37, 16384
    s_cmp_eq_u32 s27, 3
    s_cselect_b32 s85, 2147418112, s37
    s_add_u32 s37, s37, 16384
    s_cmp_eq_u32 s27, 4
    s_cselect_b32 s86, 2147418112, s37
    v_mul_u32_u24 v1, 1152, v20
    v_lshrrev_b32 v15, 5, v14
    v_lshl_add_u32 v1, v15, 4, v1
    v_add_u32 v2, 36864, v1
    s_mul_i32 s38, s26, 384
    s_lshl_b32 s39, s27, 6
    s_add_u32 s38, s38, s39
    s_mul_i32 s39, s74, 192
    s_add_u32 s38, s38, s39
    s_lshl_b32 s39, s27, 8
    s_add_u32 s39, s39, s40
    v_lshlrev_b32 v16, 2, v14
    s_mov_b32 s88, 0
    s_mov_b64 exec, 31
k2_spin:
    buffer_load_dword v17, v16, s[12:15], s39 offen sc1
    s_waitcnt vmcnt(0)
    v_cmp_eq_u32 vcc, 0, v17
    s_cbranch_vccz k2_got0
    s_sleep 1
    s_add_u32 s88, s88, 1
    s_cmp_lt_u32 s88, 0x40000
    s_cbranch_scc1 k2_spin
k2_got0:
    s_mov_b64 exec, -1
    buffer_load_dwordx4 v[32:35], v13, s[12:15], s82 offen sc1
    buffer_load_dwordx4 v[36:39], v13, s[12:15], s82 offen offset:1024 sc1
    buffer_load_dwordx4 v[40:43], v13, s[12:15], s83 offen sc1
    buffer_load_dwordx4 v[44:47], v13, s[12:15], s83 offen offset:1024 sc1
    buffer_load_dwordx4 v[48:51], v13, s[12:15], s84 offen sc1
    buffer_load_dwordx4 v[52:55], v13, s[12:15], s84 offen offset:1024 sc1
    buffer_load_dwordx4 v[56:59], v13, s[12:15], s85 offen sc1
    buffer_load_dwordx4 v[60:63], v13, s[12:15], s85 offen offset:1024 sc1
    buffer_load_dwordx4 v[64:67], v13, s[12:15], s86 offen sc1
    buffer_load_dwordx4 v[68:71], v13, s[12:15], s86 offen offset:1024 sc1
    buffer_load_dwordx4 v[192:195], v12, s[12:15], s82 offen sc1
    buffer_load_dwordx4 v[196:199], v12, s[12:15], s82 offen offset:1024 sc1
    buffer_load_dwordx4 v[200:203], v12, s[12:15], s83 offen sc1
    buffer_load_dwordx4 v[204:207], v12, s[12:15], s83 offen offset:1024 sc1
    buffer_load_dwordx4 v[208:211], v12, s[12:15], s84 offen sc1
    buffer_load_dwordx4 v[212:215], v12, s[12:15], s84 offen offset:1024 sc1
    buffer_load_dwordx4 v[216:219], v12, s[12:15], s85 offen sc1
    buffer_load_dwordx4 v[220:223], v12, s[12:15], s85 offen offset:1024 sc1
    buffer_load_dwordx4 v[224:227], v12, s[12:15], s86 offen sc1
    buffer_load_dwordx4 v[228:231], v12, s[12:15], s86 offen offset:1024 sc1
    s_waitcnt vmcnt(10)
    v_lshlrev_b32 v80, 16, v32
    v_and_b32 v81, 0xffff0000, v32
    v_pk_add_f32 v[96:97], v[96:97], v[80:81]
    v_lshlrev_b32 v82, 16, v33
    v_and_b32 v83, 0xffff0000, v33
    v_pk_add_f32 v[98:99], v[98:99], v[82:83]
    v_lshlrev_b32 v80, 16, v34
    v_and_b32 v81, 0xffff0000, v34
    v_pk_add_f32 v[100:101], v[100:101], v[80:81]
    v_lshlrev_b32 v82, 16, v35
    v_and_b32 v83, 0xffff0000, v35
    v_pk_add_f32 v[102:103], v[102:103], v[82:83]
    v_lshlrev_b32 v80, 16, v40
    v_and_b32 v81, 0xffff0000, v40
    v_pk_add_f32 v[96:97], v[96:97], v[80:81]
    v_lshlrev_b32 v82, 16, v41
    v_and_b32 v83, 0xffff0000, v41
    v_pk_add_f32 v[98:99], v[98:99], v[82:83]
    v_lshlrev_b32 v80, 16, v42
    v_and_b32 v81, 0xffff0000, v42
    v_pk_add_f32 v[100:101], v[100:101], v[80:81]
    v_lshlrev_b32 v82, 16, v43
    v_and_b32 v83, 0xffff0000, v43
    v_pk_add_f32 v[102:103], v[102:103], v[82:83]
    v_lshlrev_b32 v80, 16, v48
    v_and_b32 v81, 0xffff0000, v48
    v_pk_add_f32 v[96:97], v[96:97], v[80:81]
    v_lshlrev_b32 v82, 16, v49
    v_and_b32 v83, 0xffff0000, v49
    v_pk_add_f32 v[98:99], v[98:99], v[82:83]
    v_lshlrev_b32 v80, 16, v50
    v_and_b32 v81, 0xffff0000, v50
    v_pk_add_f32 v[100:101], v[100:101], v[80:81]
    v_lshlrev_b32 v82, 16, v51
    v_and_b32 v83, 0xffff0000, v51
    v_pk_add_f32 v[102:103], v[102:103], v[82:83]
    v_lshlrev_b32 v80, 16, v56
    v_and_b32 v81, 0xffff0000, v56
    v_pk_add_f32 v[96:97], v[96:97], v[80:81]
    v_lshlrev_b32 v82, 16, v57
    v_and_b32 v83, 0xffff0000, v57
    v_pk_add_f32 v[98:99], v[98:99], v[82:83]
    v_lshlrev_b32 v80, 16, v58
    v_and_b32 v81, 0xffff0000, v58
    v_pk_add_f32 v[100:101], v[100:101], v[80:81]
    v_lshlrev_b32 v82, 16, v59
    v_and_b32 v83, 0xffff0000, v59
    v_pk_add_f32 v[102:103], v[102:103], v[82:83]
    v_lshlrev_b32 v80, 16, v64
    v_and_b32 v81, 0xffff0000, v64
    v_pk_add_f32 v[96:97], v[96:97], v[80:81]
    v_lshlrev_b32 v82, 16, v65
    v_and_b32 v83, 0xffff0000, v65
    v_pk_add_f32 v[98:99], v[98:99], v[82:83]
    v_lshlrev_b32 v80, 16, v66
    v_and_b32 v81, 0xffff0000, v66
    v_pk_add_f32 v[100:101], v[100:101], v[80:81]
    v_lshlrev_b32 v82, 16, v67
    v_and_b32 v83, 0xffff0000, v67
    v_pk_add_f32 v[102:103], v[102:103], v[82:83]
    v_cvt_pk_bf16_f32 v84, v96, v97
    v_cvt_pk_bf16_f32 v85, v98, v99
    v_cvt_pk_bf16_f32 v86, v100, v101
    v_cvt_pk_bf16_f32 v87, v102, v103
    s_nop 1
    v_permlane32_swap_b32 v84, v86
    v_permlane32_swap_b32 v85, v87
    buffer_store_dwordx4 v[84:87], v1, s[16:19], s38 offen offset:0
    v_lshlrev_b32 v80, 16, v36
    v_and_b32 v81, 0xffff0000, v36
    v_pk_add_f32 v[104:105], v[104:105], v[80:81]
    v_lshlrev_b32 v82, 16, v37
    v_and_b32 v83, 0xffff0000, v37
    v_pk_add_f32 v[106:107], v[106:107], v[82:83]
    v_lshlrev_b32 v80, 16, v38
    v_and_b32 v81, 0xffff0000, v38
    v_pk_add_f32 v[108:109], v[108:109], v[80:81]
    v_lshlrev_b32 v82, 16, v39
    v_and_b32 v83, 0xffff0000, v39
    v_pk_add_f32 v[110:111], v[110:111], v[82:83]
    v_lshlrev_b32 v80, 16, v44
    v_and_b32 v81, 0xffff0000, v44
    v_pk_add_f32 v[104:105], v[104:105], v[80:81]
    v_lshlrev_b32 v82, 16, v45
    v_and_b32 v83, 0xffff0000, v45
    v_pk_add_f32 v[106:107], v[106:107], v[82:83]
    v_lshlrev_b32 v80, 16, v46
    v_and_b32 v81, 0xffff0000, v46
    v_pk_add_f32 v[108:109], v[108:109], v[80:81]
    v_lshlrev_b32 v82, 16, v47
    v_and_b32 v83, 0xffff0000, v47
    v_pk_add_f32 v[110:111], v[110:111], v[82:83]
    v_lshlrev_b32 v80, 16, v52
    v_and_b32 v81, 0xffff0000, v52
    v_pk_add_f32 v[104:105], v[104:105], v[80:81]
    v_lshlrev_b32 v82, 16, v53
    v_and_b32 v83, 0xffff0000, v53
    v_pk_add_f32 v[106:107], v[106:107], v[82:83]
    v_lshlrev_b32 v80, 16, v54
    v_and_b32 v81, 0xffff0000, v54
    v_pk_add_f32 v[108:109], v[108:109], v[80:81]
    v_lshlrev_b32 v82, 16, v55
    v_and_b32 v83, 0xffff0000, v55
    v_pk_add_f32 v[110:111], v[110:111], v[82:83]
    v_lshlrev_b32 v80, 16, v60
    v_and_b32 v81, 0xffff0000, v60
    v_pk_add_f32 v[104:105], v[104:105], v[80:81]
    v_lshlrev_b32 v82, 16, v61
    v_and_b32 v83, 0xffff0000, v61
    v_pk_add_f32 v[106:107], v[106:107], v[82:83]
    v_lshlrev_b32 v80, 16, v62
    v_and_b32 v81, 0xffff0000, v62
    v_pk_add_f32 v[108:109], v[108:109], v[80:81]
    v_lshlrev_b32 v82, 16, v63
    v_and_b32 v83, 0xffff0000, v63
    v_pk_add_f32 v[110:111], v[110:111], v[82:83]
    v_lshlrev_b32 v80, 16, v68
    v_and_b32 v81, 0xffff0000, v68
    v_pk_add_f32 v[104:105], v[104:105], v[80:81]
    v_lshlrev_b32 v82, 16, v69
    v_and_b32 v83, 0xffff0000, v69
    v_pk_add_f32 v[106:107], v[106:107], v[82:83]
    v_lshlrev_b32 v80, 16, v70
    v_and_b32 v81, 0xffff0000, v70
    v_pk_add_f32 v[108:109], v[108:109], v[80:81]
    v_lshlrev_b32 v82, 16, v71
    v_and_b32 v83, 0xffff0000, v71
    v_pk_add_f32 v[110:111], v[110:111], v[82:83]
    v_cvt_pk_bf16_f32 v88, v104, v105
    v_cvt_pk_bf16_f32 v89, v106, v107
    v_cvt_pk_bf16_f32 v90, v108, v109
    v_cvt_pk_bf16_f32 v91, v110, v111
    s_nop 1
    v_permlane32_swap_b32 v88, v90
    v_permlane32_swap_b32 v89, v91
    buffer_store_dwordx4 v[88:91], v1, s[16:19], s38 offen offset:32
    s_waitcnt vmcnt(2)
    v_lshlrev_b32 v80, 16, v192
    v_and_b32 v81, 0xffff0000, v192
    v_pk_add_f32 v[144:145], v[144:145], v[80:81]
    v_lshlrev_b32 v82, 16, v193
    v_and_b32 v83, 0xffff0000, v193
    v_pk_add_f32 v[146:147], v[146:147], v[82:83]
    v_lshlrev_b32 v80, 16, v194
    v_and_b32 v81, 0xffff0000, v194
    v_pk_add_f32 v[148:149], v[148:149], v[80:81]
    v_lshlrev_b32 v82, 16, v195
    v_and_b32 v83, 0xffff0000, v195
    v_pk_add_f32 v[150:151], v[150:151], v[82:83]
    v_lshlrev_b32 v80, 16, v200
    v_and_b32 v81, 0xffff0000, v200
    v_pk_add_f32 v[144:145], v[144:145], v[80:81]
    v_lshlrev_b32 v82, 16, v201
    v_and_b32 v83, 0xffff0000, v201
    v_pk_add_f32 v[146:147], v[146:147], v[82:83]
    v_lshlrev_b32 v80, 16, v202
    v_and_b32 v81, 0xffff0000, v202
    v_pk_add_f32 v[148:149], v[148:149], v[80:81]
    v_lshlrev_b32 v82, 16, v203
    v_and_b32 v83, 0xffff0000, v203
    v_pk_add_f32 v[150:151], v[150:151], v[82:83]
    v_lshlrev_b32 v80, 16, v208
    v_and_b32 v81, 0xffff0000, v208
    v_pk_add_f32 v[144:145], v[144:145], v[80:81]
    v_lshlrev_b32 v82, 16, v209
    v_and_b32 v83, 0xffff0000, v209
    v_pk_add_f32 v[146:147], v[146:147], v[82:83]
    v_lshlrev_b32 v80, 16, v210
    v_and_b32 v81, 0xffff0000, v210
    v_pk_add_f32 v[148:149], v[148:149], v[80:81]
    v_lshlrev_b32 v82, 16, v211
    v_and_b32 v83, 0xffff0000, v211
    v_pk_add_f32 v[150:151], v[150:151], v[82:83]
    v_lshlrev_b32 v80, 16, v216
    v_and_b32 v81, 0xffff0000, v216
    v_pk_add_f32 v[144:145], v[144:145], v[80:81]
    v_lshlrev_b32 v82, 16, v217
    v_and_b32 v83, 0xffff0000, v217
    v_pk_add_f32 v[146:147], v[146:147], v[82:83]
    v_lshlrev_b32 v80, 16, v218
    v_and_b32 v81, 0xffff0000, v218
    v_pk_add_f32 v[148:149], v[148:149], v[80:81]
    v_lshlrev_b32 v82, 16, v219
    v_and_b32 v83, 0xffff0000, v219
    v_pk_add_f32 v[150:151], v[150:151], v[82:83]
    v_lshlrev_b32 v80, 16, v224
    v_and_b32 v81, 0xffff0000, v224
    v_pk_add_f32 v[144:145], v[144:145], v[80:81]
    v_lshlrev_b32 v82, 16, v225
    v_and_b32 v83, 0xffff0000, v225
    v_pk_add_f32 v[146:147], v[146:147], v[82:83]
    v_lshlrev_b32 v80, 16, v226
    v_and_b32 v81, 0xffff0000, v226
    v_pk_add_f32 v[148:149], v[148:149], v[80:81]
    v_lshlrev_b32 v82, 16, v227
    v_and_b32 v83, 0xffff0000, v227
    v_pk_add_f32 v[150:151], v[150:151], v[82:83]
    v_cvt_pk_bf16_f32 v84, v144, v145
    v_cvt_pk_bf16_f32 v85, v146, v147
    v_cvt_pk_bf16_f32 v86, v148, v149
    v_cvt_pk_bf16_f32 v87, v150, v151
    s_nop 1
    v_permlane32_swap_b32 v84, v86
    v_permlane32_swap_b32 v85, v87
    buffer_store_dwordx4 v[84:87], v2, s[16:19], s38 offen offset:0
    v_lshlrev_b32 v80, 16, v196
    v_and_b32 v81, 0xffff0000, v196
    v_pk_add_f32 v[152:153], v[152:153], v[80:81]
    v_lshlrev_b32 v82, 16, v197
    v_and_b32 v83, 0xffff0000, v197
    v_pk_add_f32 v[154:155], v[154:155], v[82:83]
    v_lshlrev_b32 v80, 16, v198
    v_and_b32 v81, 0xffff0000, v198
    v_pk_add_f32 v[156:157], v[156:157], v[80:81]
    v_lshlrev_b32 v82, 16, v199
    v_and_b32 v83, 0xffff0000, v199
    v_pk_add_f32 v[158:159], v[158:159], v[82:83]
    v_lshlrev_b32 v80, 16, v204
    v_and_b32 v81, 0xffff0000, v204
    v_pk_add_f32 v[152:153], v[152:153], v[80:81]
    v_lshlrev_b32 v82, 16, v205
    v_and_b32 v83, 0xffff0000, v205
    v_pk_add_f32 v[154:155], v[154:155], v[82:83]
    v_lshlrev_b32 v80, 16, v206
    v_and_b32 v81, 0xffff0000, v206
    v_pk_add_f32 v[156:157], v[156:157], v[80:81]
    v_lshlrev_b32 v82, 16, v207
    v_and_b32 v83, 0xffff0000, v207
    v_pk_add_f32 v[158:159], v[158:159], v[82:83]
    v_lshlrev_b32 v80, 16, v212
    v_and_b32 v81, 0xffff0000, v212
    v_pk_add_f32 v[152:153], v[152:153], v[80:81]
    v_lshlrev_b32 v82, 16, v213
    v_and_b32 v83, 0xffff0000, v213
    v_pk_add_f32 v[154:155], v[154:155], v[82:83]
    v_lshlrev_b32 v80, 16, v214
    v_and_b32 v81, 0xffff0000, v214
    v_pk_add_f32 v[156:157], v[156:157], v[80:81]
    v_lshlrev_b32 v82, 16, v215
    v_and_b32 v83, 0xffff0000, v215
    v_pk_add_f32 v[158:159], v[158:159], v[82:83]
    v_lshlrev_b32 v80, 16, v220
    v_and_b32 v81, 0xffff0000, v220
    v_pk_add_f32 v[152:153], v[152:153], v[80:81]
    v_lshlrev_b32 v82, 16, v221
    v_and_b32 v83, 0xffff0000, v221
    v_pk_add_f32 v[154:155], v[154:155], v[82:83]
    v_lshlrev_b32 v80, 16, v222
    v_and_b32 v81, 0xffff0000, v222
    v_pk_add_f32 v[156:157], v[156:157], v[80:81]
    v_lshlrev_b32 v82, 16, v223
    v_and_b32 v83, 0xffff0000, v223
    v_pk_add_f32 v[158:159], v[158:159], v[82:83]
    v_lshlrev_b32 v80, 16, v228
    v_and_b32 v81, 0xffff0000, v228
    v_pk_add_f32 v[152:153], v[152:153], v[80:81]
    v_lshlrev_b32 v82, 16, v229
    v_and_b32 v83, 0xffff0000, v229
    v_pk_add_f32 v[154:155], v[154:155], v[82:83]
    v_lshlrev_b32 v80, 16, v230
    v_and_b32 v81, 0xffff0000, v230
    v_pk_add_f32 v[156:157], v[156:157], v[80:81]
    v_lshlrev_b32 v82, 16, v231
    v_and_b32 v83, 0xffff0000, v231
    v_pk_add_f32 v[158:159], v[158:159], v[82:83]
    v_cvt_pk_bf16_f32 v88, v152, v153
    v_cvt_pk_bf16_f32 v89, v154, v155
    v_cvt_pk_bf16_f32 v90, v156, v157
    v_cvt_pk_bf16_f32 v91, v158, v159
    s_nop 1
    v_permlane32_swap_b32 v88, v90
    v_permlane32_swap_b32 v89, v91
    buffer_store_dwordx4 v[88:91], v2, s[16:19], s38 offen offset:32
k2_exit2:
k2_exit:
    s_endpgm

code_end:
    s_endpgm
```
